```python
import torch

def _softmax(x, axis=-1):
    return torch.softmax(x, dim=axis)
def _gelu(x):
    return torch.nn.functional.gelu(x, approximate="tanh")
def _silu(x):
    return torch.nn.functional.silu(x)
def _sigmoid(x):
    return torch.sigmoid(x)
def _layernorm(x, axis=-1, eps=1e-5):
    m = x.mean(dim=axis, keepdim=True)
    v = x.var(dim=axis, keepdim=True, unbiased=False)
    return (x - m) / torch.sqrt(v + eps)
def _scatter_add(tgt, idx, src, axis=0):
    return tgt.clone().index_add_(axis, idx, src)
def _segment_sum(src, seg, n):
    out = torch.zeros((n,) + src.shape[1:], dtype=src.dtype)
    return out.index_add_(0, seg, src)
def _pad(x, pw):
    flat = tuple(v for pair in reversed(pw) for v in pair)
    return torch.nn.functional.pad(x, flat)

kernel_name = 'concat_heads__mha_block_cached__gqa_block_cached__near_ridge'

def setup_inputs():

    _w = (lambda a: (lambda t: t.to(torch.bfloat16) if t.is_floating_point() else t)(torch.as_tensor(a)))
    def _A_setup():
        B, Sq, D = 8, 192, 512
        H, Sk, Dh = 32, 1024, 128
        return {
            "x": _w((lambda *s: torch.randn(*s, dtype=torch.bfloat16) * 0.8)(B, Sq, D)),
            "k_cache": _w((lambda *s: torch.randn(*s, dtype=torch.bfloat16) * 0.8)(B, H, Sk, Dh)),
            "v_cache": _w((lambda *s: torch.randn(*s, dtype=torch.bfloat16) * 0.05)(B, H, Sk, Dh)),
            "wq": _w((lambda *s: torch.randn(*s, dtype=torch.bfloat16) * 0.8)(D, H * Dh) * (D ** -0.5)),
            "wo": _w((lambda *s: torch.randn(*s, dtype=torch.bfloat16) * 0.05)(H * Dh, D) * ((H * Dh) ** -0.5)),
        }
    _A_in = _A_setup()

    def _B_setup():
        B, Sq, D = 8, 192, 512
        Hq, Hkv, Sk, Dh = 32, 32, 1024, 128
        assert Hq % Hkv == 0, (Hq, Hkv)
        return {
            "x": _w((lambda *s: torch.randn(*s, dtype=torch.bfloat16) * 0.8)(B, Sq, D)),
            "k_cache": _w((lambda *s: torch.randn(*s, dtype=torch.bfloat16) * 0.8)(B, Hkv, Sk, Dh)),
            "v_cache": _w((lambda *s: torch.randn(*s, dtype=torch.bfloat16) * 0.05)(B, Hkv, Sk, Dh)),
            "wq": _w((lambda *s: torch.randn(*s, dtype=torch.bfloat16) * 0.8)(D, Hq * Dh) * (D ** -0.5)),
            "wo": _w((lambda *s: torch.randn(*s, dtype=torch.bfloat16) * 0.05)(Hq * Dh, D) * ((Hq * Dh) ** -0.5)),
        }
    _B_in = _B_setup()

    return {
        "A_x": _A_in["x"],
        "A_k_cache": _A_in["k_cache"],
        "A_v_cache": _A_in["v_cache"],
        "A_wq": _A_in["wq"],
        "A_wo": _A_in["wo"],
        "B_x": _B_in["x"],
        "B_k_cache": _B_in["k_cache"],
        "B_v_cache": _B_in["v_cache"],
        "B_wq": _B_in["wq"],
        "B_wo": _B_in["wo"],
    }

def reference(A_x, A_k_cache, A_v_cache, A_wq, A_wo, B_x, B_k_cache, B_v_cache, B_wq, B_wo):
    def _A_ref(x, k_cache, v_cache, wq, wo):
        B, Sq, D = x.shape
        H, Dh = 32, 128
        q = (lambda x, *d: x.permute(*d))((x @ wq).reshape(B, Sq, H, Dh), 0, 2, 1, 3)
        scores = torch.einsum("bhqd,bhkd->bhqk", q, k_cache) * (Dh ** -0.5)
        p = _softmax(scores, axis=-1)
        o = torch.einsum("bhqk,bhkd->bhqd", p, v_cache)
        return (lambda x, *d: x.permute(*d))(o, 0, 2, 1, 3).reshape(B, Sq, H * Dh) @ wo

    def _B_ref(x, k_cache, v_cache, wq, wo):
        B, Sq, D = x.shape
        Hq, Dh = 32, 128
        Hkv = k_cache.shape[1]
        rep = Hq // Hkv
        q = (lambda x, *d: x.permute(*d))((x @ wq).reshape(B, Sq, Hq, Dh), 0, 2, 1, 3)
        k = (lambda x, n, axis: torch.repeat_interleave(x, n, dim=axis))(k_cache, rep, axis=1)
        v = (lambda x, n, axis: torch.repeat_interleave(x, n, dim=axis))(v_cache, rep, axis=1)
        scores = torch.einsum("bhqd,bhkd->bhqk", q, k) * (Dh ** -0.5)
        p = _softmax(scores, axis=-1)
        o = torch.einsum("bhqk,bhkd->bhqd", p, v)
        return (lambda x, *d: x.permute(*d))(o, 0, 2, 1, 3).reshape(B, Sq, Hq * Dh) @ wo

    a = _A_ref(A_x, A_k_cache, A_v_cache, A_wq, A_wo)
    b = _B_ref(B_x, B_k_cache, B_v_cache, B_wq, B_wo)
    return torch.concatenate([a, b], axis=-1)
```

```asm
; @launch kernel=attn_kernel grid=(512,1,1) block=(256,1,1) lds=65536
; @launch kernel=oproj_kernel grid=(256,1,1) block=(256,1,1) lds=163840
; @launch kernel=reduce_kernel grid=(768,1,1) block=(256,1,1) lds=0
.amdgcn_target "amdgcn-amd-amdhsa--gfx950"
.text
.globl attn_kernel
.p2align 8
.type attn_kernel,@function
attn_kernel:
    s_cmp_ge_u32 s2, 512
    s_cbranch_scc1 L_attn_end
    s_lshr_b32 s3, s2, 8
    s_mul_i32 s3, s3, 40
    s_add_u32 s4, s0, s3
    s_addc_u32 s5, s1, 0
    s_load_dwordx8 s[36:43], s[4:5], 0
    s_load_dwordx2 s[44:45], s[0:1], 96
    v_lshrrev_b32 v1, 6, v0
    s_nop 0
    v_readfirstlane_b32 s28, v1
    s_and_b32 s6, s2, 255
    s_lshl_b32 s7, s6, 18
    s_lshr_b32 s46, s6, 5
    s_and_b32 s47, s6, 31
    s_lshr_b32 s48, s2, 8
    s_waitcnt lgkmcnt(0)
    s_add_u32 s8, s38, s7
    s_addc_u32 s9, s39, 0
    s_mov_b32 s10, 262144
    s_mov_b32 s11, 0x00020000
    s_add_u32 s12, s40, s7
    s_addc_u32 s13, s41, 0
    s_mov_b32 s14, 262144
    s_mov_b32 s15, 0x00020000
    s_lshl_b32 s49, s47, 8
    s_add_u32 s16, s42, s49
    s_addc_u32 s17, s43, 0
    s_mov_b32 s18, 4186368
    s_mov_b32 s19, 0x00020000
    s_mul_i32 s50, s46, 196608
    s_add_u32 s20, s36, s50
    s_addc_u32 s21, s37, 0
    s_mov_b32 s22, 196608
    s_mov_b32 s23, 0x00020000
    s_mul_i32 s51, s48, 12582912
    s_mul_i32 s52, s46, 1572864
    s_add_u32 s51, s51, s52
    s_lshl_b32 s52, s47, 12
    s_add_u32 s51, s51, s52
    s_add_u32 s24, s44, s51
    s_addc_u32 s25, s45, 0
    s_mov_b32 s26, 1445888
    s_mov_b32 s27, 0x00020000
    s_lshl_b32 s29, s28, 12
    s_mul_i32 s35, s2, 5
    s_lshr_b32 s32, s2, 4
    s_add_u32 s35, s35, s32
    s_and_b32 s35, s35, 15
    s_mov_b32 s33, 0x3e0293ee
    s_lshr_b32 s58, s2, 3
    s_and_b32 s58, s58, 7
    v_mbcnt_lo_u32_b32 v244, -1, 0
    v_mbcnt_hi_u32_b32 v244, -1, v244
    v_lshrrev_b32 v245, 4, v244
    v_and_b32 v246, 15, v244
    v_and_b32 v247, 7, v246
    v_lshlrev_b32 v247, 1, v247
    v_add_u32 v248, 0, v245
    v_xor_b32 v248, v248, v247
    v_lshlrev_b32 v248, 4, v248
    v_lshl_add_u32 v224, v246, 8, v248
    v_add_u32 v248, 4, v245
    v_xor_b32 v248, v248, v247
    v_lshlrev_b32 v248, 4, v248
    v_lshl_add_u32 v225, v246, 8, v248
    v_add_u32 v248, 8, v245
    v_xor_b32 v248, v248, v247
    v_lshlrev_b32 v248, 4, v248
    v_lshl_add_u32 v226, v246, 8, v248
    v_add_u32 v248, 12, v245
    v_xor_b32 v248, v248, v247
    v_lshlrev_b32 v248, 4, v248
    v_lshl_add_u32 v227, v246, 8, v248
    v_lshrrev_b32 v247, 2, v246
    v_lshl_add_u32 v247, v245, 2, v247
    v_and_b32 v248, 7, v247
    v_lshlrev_b32 v248, 1, v248
    v_and_b32 v249, 3, v246
    v_lshrrev_b32 v250, 1, v249
    v_and_b32 v249, 1, v249
    v_lshlrev_b32 v249, 3, v249
    v_lshl_add_u32 v249, v247, 8, v249
    v_add_u32 v251, 0, v250
    v_xor_b32 v251, v251, v248
    v_lshl_add_u32 v228, v251, 4, v249
    v_add_u32 v251, 2, v250
    v_xor_b32 v251, v251, v248
    v_lshl_add_u32 v229, v251, 4, v249
    v_add_u32 v251, 4, v250
    v_xor_b32 v251, v251, v248
    v_lshl_add_u32 v230, v251, 4, v249
    v_add_u32 v251, 6, v250
    v_xor_b32 v251, v251, v248
    v_lshl_add_u32 v231, v251, 4, v249
    v_add_u32 v251, 8, v250
    v_xor_b32 v251, v251, v248
    v_lshl_add_u32 v232, v251, 4, v249
    v_add_u32 v251, 10, v250
    v_xor_b32 v251, v251, v248
    v_lshl_add_u32 v233, v251, 4, v249
    v_add_u32 v251, 12, v250
    v_xor_b32 v251, v251, v248
    v_lshl_add_u32 v234, v251, 4, v249
    v_add_u32 v251, 14, v250
    v_xor_b32 v251, v251, v248
    v_lshl_add_u32 v235, v251, 4, v249
    v_mbcnt_lo_u32_b32 v244, -1, 0
    v_mbcnt_hi_u32_b32 v244, -1, v244
    v_lshrrev_b32 v245, 4, v244
    v_and_b32 v246, 15, v244
    v_lshlrev_b32 v247, 1, v245
    v_xor_b32 v248, v246, v247
    v_lshlrev_b32 v248, 4, v248
    v_add_u32 v247, 8, v247
    v_xor_b32 v249, v246, v247
    v_lshlrev_b32 v249, 4, v249
    s_lshr_b32 s55, s28, 1
    s_lshl_b32 s55, s55, 5
    s_and_b32 s56, s28, 1
    s_lshl_b32 s56, s56, 2
    s_add_u32 s55, s55, s56
    v_add_u32 v245, s55, v245
    v_lshlrev_b32 v245, 13, v245
    v_add_u32 v251, v245, v248
    v_add_u32 v252, v245, v249
    v_mbcnt_lo_u32_b32 v244, -1, 0
    v_mbcnt_hi_u32_b32 v244, -1, v244
    v_and_b32 v245, 15, v244
    v_lshrrev_b32 v246, 4, v244
    s_mul_i32 s32, s28, 48
    v_add_u32 v245, s32, v245
    v_lshlrev_b32 v245, 10, v245
    v_lshl_add_u32 v253, v246, 4, v245
    v_add_u32 v254, 0x4000, v253
    v_add_u32 v255, 0x8000, v253
    v_mov_b32 v0, 0
    v_mov_b32 v1, 0
    v_mov_b32 v2, 0
    v_mov_b32 v3, 0
    v_mov_b32 v4, 0
    v_mov_b32 v5, 0
    v_mov_b32 v6, 0
    v_mov_b32 v7, 0
    v_mov_b32 v8, 0
    v_mov_b32 v9, 0
    v_mov_b32 v10, 0
    v_mov_b32 v11, 0
    v_mov_b32 v12, 0
    v_mov_b32 v13, 0
    v_mov_b32 v14, 0
    v_mov_b32 v15, 0
    v_mov_b32 v16, 0
    v_mov_b32 v17, 0
    v_mov_b32 v18, 0
    v_mov_b32 v19, 0
    v_mov_b32 v20, 0
    v_mov_b32 v21, 0
    v_mov_b32 v22, 0
    v_mov_b32 v23, 0
    v_mov_b32 v24, 0
    v_mov_b32 v25, 0
    v_mov_b32 v26, 0
    v_mov_b32 v27, 0
    v_mov_b32 v28, 0
    v_mov_b32 v29, 0
    v_mov_b32 v30, 0
    v_mov_b32 v31, 0
    v_mov_b32 v32, 0
    v_mov_b32 v33, 0
    v_mov_b32 v34, 0
    v_mov_b32 v35, 0
    v_mov_b32 v36, 0
    v_mov_b32 v37, 0
    v_mov_b32 v38, 0
    v_mov_b32 v39, 0
    v_mov_b32 v40, 0
    v_mov_b32 v41, 0
    v_mov_b32 v42, 0
    v_mov_b32 v43, 0
    v_mov_b32 v44, 0
    v_mov_b32 v45, 0
    v_mov_b32 v46, 0
    v_mov_b32 v47, 0
    v_mov_b32 v48, 0
    v_mov_b32 v49, 0
    v_mov_b32 v50, 0
    v_mov_b32 v51, 0
    v_mov_b32 v52, 0
    v_mov_b32 v53, 0
    v_mov_b32 v54, 0
    v_mov_b32 v55, 0
    v_mov_b32 v56, 0
    v_mov_b32 v57, 0
    v_mov_b32 v58, 0
    v_mov_b32 v59, 0
    v_mov_b32 v60, 0
    v_mov_b32 v61, 0
    v_mov_b32 v62, 0
    v_mov_b32 v63, 0
    v_mov_b32 v64, 0
    v_mov_b32 v65, 0
    v_mov_b32 v66, 0
    v_mov_b32 v67, 0
    v_mov_b32 v68, 0
    v_mov_b32 v69, 0
    v_mov_b32 v70, 0
    v_mov_b32 v71, 0
    v_mov_b32 v72, 0
    v_mov_b32 v73, 0
    v_mov_b32 v74, 0
    v_mov_b32 v75, 0
    v_mov_b32 v76, 0
    v_mov_b32 v77, 0
    v_mov_b32 v78, 0
    v_mov_b32 v79, 0
    v_mov_b32 v80, 0
    v_mov_b32 v81, 0
    v_mov_b32 v82, 0
    v_mov_b32 v83, 0
    v_mov_b32 v84, 0
    v_mov_b32 v85, 0
    v_mov_b32 v86, 0
    v_mov_b32 v87, 0
    v_mov_b32 v88, 0
    v_mov_b32 v89, 0
    v_mov_b32 v90, 0
    v_mov_b32 v91, 0
    v_mov_b32 v92, 0
    v_mov_b32 v93, 0
    v_mov_b32 v94, 0
    v_mov_b32 v95, 0
    v_mbcnt_lo_u32_b32 v244, -1, 0
    v_mbcnt_hi_u32_b32 v244, -1, v244
    v_lshrrev_b32 v245, 4, v244
    v_and_b32 v246, 15, v244
    v_lshlrev_b32 v247, 1, v245
    v_xor_b32 v248, v246, v247
    v_lshlrev_b32 v248, 4, v248
    v_add_u32 v247, 8, v247
    v_xor_b32 v249, v246, v247
    v_lshlrev_b32 v249, 4, v249
    v_lshl_add_u32 v245, s28, 4, v245
    v_lshlrev_b32 v245, 8, v245
    v_add_u32 v236, v245, v248
    v_add_u32 v237, v245, v249
    s_add_u32 m0, s29, 0
    s_add_u32 s57, s58, 0
    s_and_b32 s57, s57, 7
    s_lshl_b32 s57, s57, 19
    s_add_u32 s32, s57, 0
    buffer_load_dwordx4 v251, s[16:19], s32 offen offset:0 lds
    s_add_u32 s32, s57, 64512
    buffer_load_dwordx4 v252, s[16:19], s32 offen offset:1024 lds
    s_add_u32 s32, s57, 129024
    buffer_load_dwordx4 v251, s[16:19], s32 offen offset:2048 lds
    s_add_u32 s32, s57, 193536
    buffer_load_dwordx4 v252, s[16:19], s32 offen offset:3072 lds
    s_add_u32 s57, s58, 0
    s_and_b32 s57, s57, 7
    s_lshl_b32 s57, s57, 7
    buffer_load_dwordx4 v[96:99], v253, s[20:23], s57 offen offset:0
    buffer_load_dwordx4 v[100:103], v254, s[20:23], s57 offen offset:0
    buffer_load_dwordx4 v[104:107], v255, s[20:23], s57 offen offset:0
    buffer_load_dwordx4 v[108:111], v253, s[20:23], s57 offen offset:64
    buffer_load_dwordx4 v[112:115], v254, s[20:23], s57 offen offset:64
    buffer_load_dwordx4 v[116:119], v255, s[20:23], s57 offen offset:64
    s_add_u32 m0, s29, 16384
    s_add_u32 s57, s58, 1
    s_and_b32 s57, s57, 7
    s_lshl_b32 s57, s57, 19
    s_add_u32 s32, s57, 0
    buffer_load_dwordx4 v251, s[16:19], s32 offen offset:0 lds
    s_add_u32 s32, s57, 64512
    buffer_load_dwordx4 v252, s[16:19], s32 offen offset:1024 lds
    s_add_u32 s32, s57, 129024
    buffer_load_dwordx4 v251, s[16:19], s32 offen offset:2048 lds
    s_add_u32 s32, s57, 193536
    buffer_load_dwordx4 v252, s[16:19], s32 offen offset:3072 lds
    s_add_u32 s57, s58, 1
    s_and_b32 s57, s57, 7
    s_lshl_b32 s57, s57, 7
    buffer_load_dwordx4 v[120:123], v253, s[20:23], s57 offen offset:0
    buffer_load_dwordx4 v[124:127], v254, s[20:23], s57 offen offset:0
    buffer_load_dwordx4 v[128:131], v255, s[20:23], s57 offen offset:0
    buffer_load_dwordx4 v[132:135], v253, s[20:23], s57 offen offset:64
    buffer_load_dwordx4 v[136:139], v254, s[20:23], s57 offen offset:64
    buffer_load_dwordx4 v[140:143], v255, s[20:23], s57 offen offset:64
    s_add_u32 m0, s29, 32768
    s_add_u32 s57, s58, 2
    s_and_b32 s57, s57, 7
    s_lshl_b32 s57, s57, 19
    s_add_u32 s32, s57, 0
    buffer_load_dwordx4 v251, s[16:19], s32 offen offset:0 lds
    s_add_u32 s32, s57, 64512
    buffer_load_dwordx4 v252, s[16:19], s32 offen offset:1024 lds
    s_add_u32 s32, s57, 129024
    buffer_load_dwordx4 v251, s[16:19], s32 offen offset:2048 lds
    s_add_u32 s32, s57, 193536
    buffer_load_dwordx4 v252, s[16:19], s32 offen offset:3072 lds
    s_add_u32 s57, s58, 2
    s_and_b32 s57, s57, 7
    s_lshl_b32 s57, s57, 7
    buffer_load_dwordx4 v[144:147], v253, s[20:23], s57 offen offset:0
    buffer_load_dwordx4 v[148:151], v254, s[20:23], s57 offen offset:0
    buffer_load_dwordx4 v[152:155], v255, s[20:23], s57 offen offset:0
    buffer_load_dwordx4 v[156:159], v253, s[20:23], s57 offen offset:64
    buffer_load_dwordx4 v[160:163], v254, s[20:23], s57 offen offset:64
    buffer_load_dwordx4 v[164:167], v255, s[20:23], s57 offen offset:64
    s_waitcnt vmcnt(20)
    s_barrier
    s_add_u32 m0, s29, 49152
    s_add_u32 s57, s58, 3
    s_and_b32 s57, s57, 7
    s_lshl_b32 s57, s57, 19
    s_add_u32 s32, s57, 0
    buffer_load_dwordx4 v251, s[16:19], s32 offen offset:0 lds
    s_add_u32 s32, s57, 64512
    buffer_load_dwordx4 v252, s[16:19], s32 offen offset:1024 lds
    s_add_u32 s32, s57, 129024
    buffer_load_dwordx4 v251, s[16:19], s32 offen offset:2048 lds
    s_add_u32 s32, s57, 193536
    buffer_load_dwordx4 v252, s[16:19], s32 offen offset:3072 lds
    s_add_u32 s57, s58, 3
    s_and_b32 s57, s57, 7
    s_lshl_b32 s57, s57, 7
    buffer_load_dwordx4 v[168:171], v253, s[20:23], s57 offen offset:0
    buffer_load_dwordx4 v[172:175], v254, s[20:23], s57 offen offset:0
    buffer_load_dwordx4 v[176:179], v255, s[20:23], s57 offen offset:0
    buffer_load_dwordx4 v[180:183], v253, s[20:23], s57 offen offset:64
    buffer_load_dwordx4 v[184:187], v254, s[20:23], s57 offen offset:64
    buffer_load_dwordx4 v[188:191], v255, s[20:23], s57 offen offset:64
    ds_read_b64_tr_b16 v[192:193], v228 offset:0
    ds_read_b64_tr_b16 v[194:195], v228 offset:4096
    ds_read_b64_tr_b16 v[196:197], v229 offset:0
    ds_read_b64_tr_b16 v[198:199], v229 offset:4096
    ds_read_b64_tr_b16 v[200:201], v230 offset:0
    ds_read_b64_tr_b16 v[202:203], v230 offset:4096
    ds_read_b64_tr_b16 v[204:205], v231 offset:0
    ds_read_b64_tr_b16 v[206:207], v231 offset:4096
    ds_read_b64_tr_b16 v[208:209], v232 offset:0
    ds_read_b64_tr_b16 v[210:211], v232 offset:4096
    ds_read_b64_tr_b16 v[212:213], v233 offset:0
    ds_read_b64_tr_b16 v[214:215], v233 offset:4096
    ds_read_b64_tr_b16 v[216:217], v234 offset:0
    ds_read_b64_tr_b16 v[218:219], v234 offset:4096
    s_waitcnt lgkmcnt(12)
    v_mfma_f32_16x16x32_bf16 v[0:3], v[192:195], v[96:99], v[0:3]
    v_mfma_f32_16x16x32_bf16 v[4:7], v[192:195], v[100:103], v[4:7]
    v_mfma_f32_16x16x32_bf16 v[8:11], v[192:195], v[104:107], v[8:11]
    ds_read_b64_tr_b16 v[220:221], v235 offset:0
    ds_read_b64_tr_b16 v[222:223], v235 offset:4096
    s_waitcnt lgkmcnt(12)
    v_mfma_f32_16x16x32_bf16 v[12:15], v[196:199], v[96:99], v[12:15]
    v_mfma_f32_16x16x32_bf16 v[16:19], v[196:199], v[100:103], v[16:19]
    v_mfma_f32_16x16x32_bf16 v[20:23], v[196:199], v[104:107], v[20:23]
    ds_read_b64_tr_b16 v[192:193], v228 offset:8192
    ds_read_b64_tr_b16 v[194:195], v228 offset:12288
    s_waitcnt lgkmcnt(12)
    v_mfma_f32_16x16x32_bf16 v[24:27], v[200:203], v[96:99], v[24:27]
    v_mfma_f32_16x16x32_bf16 v[28:31], v[200:203], v[100:103], v[28:31]
    v_mfma_f32_16x16x32_bf16 v[32:35], v[200:203], v[104:107], v[32:35]
    ds_read_b64_tr_b16 v[196:197], v229 offset:8192
    ds_read_b64_tr_b16 v[198:199], v229 offset:12288
    s_waitcnt lgkmcnt(12)
    v_mfma_f32_16x16x32_bf16 v[36:39], v[204:207], v[96:99], v[36:39]
    v_mfma_f32_16x16x32_bf16 v[40:43], v[204:207], v[100:103], v[40:43]
    v_mfma_f32_16x16x32_bf16 v[44:47], v[204:207], v[104:107], v[44:47]
    ds_read_b64_tr_b16 v[200:201], v230 offset:8192
    ds_read_b64_tr_b16 v[202:203], v230 offset:12288
    s_waitcnt lgkmcnt(12)
    v_mfma_f32_16x16x32_bf16 v[48:51], v[208:211], v[96:99], v[48:51]
    v_mfma_f32_16x16x32_bf16 v[52:55], v[208:211], v[100:103], v[52:55]
    v_mfma_f32_16x16x32_bf16 v[56:59], v[208:211], v[104:107], v[56:59]
    ds_read_b64_tr_b16 v[204:205], v231 offset:8192
    ds_read_b64_tr_b16 v[206:207], v231 offset:12288
    s_waitcnt lgkmcnt(12)
    v_mfma_f32_16x16x32_bf16 v[60:63], v[212:215], v[96:99], v[60:63]
    v_mfma_f32_16x16x32_bf16 v[64:67], v[212:215], v[100:103], v[64:67]
    v_mfma_f32_16x16x32_bf16 v[68:71], v[212:215], v[104:107], v[68:71]
    ds_read_b64_tr_b16 v[208:209], v232 offset:8192
    ds_read_b64_tr_b16 v[210:211], v232 offset:12288
    s_waitcnt lgkmcnt(12)
    v_mfma_f32_16x16x32_bf16 v[72:75], v[216:219], v[96:99], v[72:75]
    v_mfma_f32_16x16x32_bf16 v[76:79], v[216:219], v[100:103], v[76:79]
    v_mfma_f32_16x16x32_bf16 v[80:83], v[216:219], v[104:107], v[80:83]
    ds_read_b64_tr_b16 v[212:213], v233 offset:8192
    ds_read_b64_tr_b16 v[214:215], v233 offset:12288
    s_waitcnt lgkmcnt(12)
    v_mfma_f32_16x16x32_bf16 v[84:87], v[220:223], v[96:99], v[84:87]
    v_mfma_f32_16x16x32_bf16 v[88:91], v[220:223], v[100:103], v[88:91]
    v_mfma_f32_16x16x32_bf16 v[92:95], v[220:223], v[104:107], v[92:95]
    ds_read_b64_tr_b16 v[216:217], v234 offset:8192
    ds_read_b64_tr_b16 v[218:219], v234 offset:12288
    s_waitcnt lgkmcnt(12)
    v_mfma_f32_16x16x32_bf16 v[0:3], v[192:195], v[108:111], v[0:3]
    v_mfma_f32_16x16x32_bf16 v[4:7], v[192:195], v[112:115], v[4:7]
    v_mfma_f32_16x16x32_bf16 v[8:11], v[192:195], v[116:119], v[8:11]
    ds_read_b64_tr_b16 v[220:221], v235 offset:8192
    ds_read_b64_tr_b16 v[222:223], v235 offset:12288
    s_waitcnt lgkmcnt(12)
    v_mfma_f32_16x16x32_bf16 v[12:15], v[196:199], v[108:111], v[12:15]
    v_mfma_f32_16x16x32_bf16 v[16:19], v[196:199], v[112:115], v[16:19]
    v_mfma_f32_16x16x32_bf16 v[20:23], v[196:199], v[116:119], v[20:23]
    s_waitcnt lgkmcnt(10)
    v_mfma_f32_16x16x32_bf16 v[24:27], v[200:203], v[108:111], v[24:27]
    v_mfma_f32_16x16x32_bf16 v[28:31], v[200:203], v[112:115], v[28:31]
    v_mfma_f32_16x16x32_bf16 v[32:35], v[200:203], v[116:119], v[32:35]
    s_waitcnt lgkmcnt(8)
    v_mfma_f32_16x16x32_bf16 v[36:39], v[204:207], v[108:111], v[36:39]
    v_mfma_f32_16x16x32_bf16 v[40:43], v[204:207], v[112:115], v[40:43]
    v_mfma_f32_16x16x32_bf16 v[44:47], v[204:207], v[116:119], v[44:47]
    s_waitcnt lgkmcnt(6)
    v_mfma_f32_16x16x32_bf16 v[48:51], v[208:211], v[108:111], v[48:51]
    v_mfma_f32_16x16x32_bf16 v[52:55], v[208:211], v[112:115], v[52:55]
    v_mfma_f32_16x16x32_bf16 v[56:59], v[208:211], v[116:119], v[56:59]
    s_waitcnt lgkmcnt(4)
    v_mfma_f32_16x16x32_bf16 v[60:63], v[212:215], v[108:111], v[60:63]
    v_mfma_f32_16x16x32_bf16 v[64:67], v[212:215], v[112:115], v[64:67]
    v_mfma_f32_16x16x32_bf16 v[68:71], v[212:215], v[116:119], v[68:71]
    s_waitcnt lgkmcnt(2)
    v_mfma_f32_16x16x32_bf16 v[72:75], v[216:219], v[108:111], v[72:75]
    v_mfma_f32_16x16x32_bf16 v[76:79], v[216:219], v[112:115], v[76:79]
    v_mfma_f32_16x16x32_bf16 v[80:83], v[216:219], v[116:119], v[80:83]
    s_waitcnt lgkmcnt(0)
    v_mfma_f32_16x16x32_bf16 v[84:87], v[220:223], v[108:111], v[84:87]
    v_mfma_f32_16x16x32_bf16 v[88:91], v[220:223], v[112:115], v[88:91]
    v_mfma_f32_16x16x32_bf16 v[92:95], v[220:223], v[116:119], v[92:95]
    s_waitcnt vmcnt(20)
    s_barrier
    s_add_u32 m0, s29, 0
    s_add_u32 s57, s58, 4
    s_and_b32 s57, s57, 7
    s_lshl_b32 s57, s57, 19
    s_add_u32 s32, s57, 0
    buffer_load_dwordx4 v251, s[16:19], s32 offen offset:0 lds
    s_add_u32 s32, s57, 64512
    buffer_load_dwordx4 v252, s[16:19], s32 offen offset:1024 lds
    s_add_u32 s32, s57, 129024
    buffer_load_dwordx4 v251, s[16:19], s32 offen offset:2048 lds
    s_add_u32 s32, s57, 193536
    buffer_load_dwordx4 v252, s[16:19], s32 offen offset:3072 lds
    s_add_u32 s57, s58, 4
    s_and_b32 s57, s57, 7
    s_lshl_b32 s57, s57, 7
    buffer_load_dwordx4 v[96:99], v253, s[20:23], s57 offen offset:0
    buffer_load_dwordx4 v[100:103], v254, s[20:23], s57 offen offset:0
    buffer_load_dwordx4 v[104:107], v255, s[20:23], s57 offen offset:0
    buffer_load_dwordx4 v[108:111], v253, s[20:23], s57 offen offset:64
    buffer_load_dwordx4 v[112:115], v254, s[20:23], s57 offen offset:64
    buffer_load_dwordx4 v[116:119], v255, s[20:23], s57 offen offset:64
    ds_read_b64_tr_b16 v[192:193], v228 offset:16384
    ds_read_b64_tr_b16 v[194:195], v228 offset:20480
    ds_read_b64_tr_b16 v[196:197], v229 offset:16384
    ds_read_b64_tr_b16 v[198:199], v229 offset:20480
    ds_read_b64_tr_b16 v[200:201], v230 offset:16384
    ds_read_b64_tr_b16 v[202:203], v230 offset:20480
    ds_read_b64_tr_b16 v[204:205], v231 offset:16384
    ds_read_b64_tr_b16 v[206:207], v231 offset:20480
    ds_read_b64_tr_b16 v[208:209], v232 offset:16384
    ds_read_b64_tr_b16 v[210:211], v232 offset:20480
    ds_read_b64_tr_b16 v[212:213], v233 offset:16384
    ds_read_b64_tr_b16 v[214:215], v233 offset:20480
    ds_read_b64_tr_b16 v[216:217], v234 offset:16384
    ds_read_b64_tr_b16 v[218:219], v234 offset:20480
    s_waitcnt lgkmcnt(12)
    v_mfma_f32_16x16x32_bf16 v[0:3], v[192:195], v[120:123], v[0:3]
    v_mfma_f32_16x16x32_bf16 v[4:7], v[192:195], v[124:127], v[4:7]
    v_mfma_f32_16x16x32_bf16 v[8:11], v[192:195], v[128:131], v[8:11]
    ds_read_b64_tr_b16 v[220:221], v235 offset:16384
    ds_read_b64_tr_b16 v[222:223], v235 offset:20480
    s_waitcnt lgkmcnt(12)
    v_mfma_f32_16x16x32_bf16 v[12:15], v[196:199], v[120:123], v[12:15]
    v_mfma_f32_16x16x32_bf16 v[16:19], v[196:199], v[124:127], v[16:19]
    v_mfma_f32_16x16x32_bf16 v[20:23], v[196:199], v[128:131], v[20:23]
    ds_read_b64_tr_b16 v[192:193], v228 offset:24576
    ds_read_b64_tr_b16 v[194:195], v228 offset:28672
    s_waitcnt lgkmcnt(12)
    v_mfma_f32_16x16x32_bf16 v[24:27], v[200:203], v[120:123], v[24:27]
    v_mfma_f32_16x16x32_bf16 v[28:31], v[200:203], v[124:127], v[28:31]
    v_mfma_f32_16x16x32_bf16 v[32:35], v[200:203], v[128:131], v[32:35]
    ds_read_b64_tr_b16 v[196:197], v229 offset:24576
    ds_read_b64_tr_b16 v[198:199], v229 offset:28672
    s_waitcnt lgkmcnt(12)
    v_mfma_f32_16x16x32_bf16 v[36:39], v[204:207], v[120:123], v[36:39]
    v_mfma_f32_16x16x32_bf16 v[40:43], v[204:207], v[124:127], v[40:43]
    v_mfma_f32_16x16x32_bf16 v[44:47], v[204:207], v[128:131], v[44:47]
    ds_read_b64_tr_b16 v[200:201], v230 offset:24576
    ds_read_b64_tr_b16 v[202:203], v230 offset:28672
    s_waitcnt lgkmcnt(12)
    v_mfma_f32_16x16x32_bf16 v[48:51], v[208:211], v[120:123], v[48:51]
    v_mfma_f32_16x16x32_bf16 v[52:55], v[208:211], v[124:127], v[52:55]
    v_mfma_f32_16x16x32_bf16 v[56:59], v[208:211], v[128:131], v[56:59]
    ds_read_b64_tr_b16 v[204:205], v231 offset:24576
    ds_read_b64_tr_b16 v[206:207], v231 offset:28672
    s_waitcnt lgkmcnt(12)
    v_mfma_f32_16x16x32_bf16 v[60:63], v[212:215], v[120:123], v[60:63]
    v_mfma_f32_16x16x32_bf16 v[64:67], v[212:215], v[124:127], v[64:67]
    v_mfma_f32_16x16x32_bf16 v[68:71], v[212:215], v[128:131], v[68:71]
    ds_read_b64_tr_b16 v[208:209], v232 offset:24576
    ds_read_b64_tr_b16 v[210:211], v232 offset:28672
    s_waitcnt lgkmcnt(12)
    v_mfma_f32_16x16x32_bf16 v[72:75], v[216:219], v[120:123], v[72:75]
    v_mfma_f32_16x16x32_bf16 v[76:79], v[216:219], v[124:127], v[76:79]
    v_mfma_f32_16x16x32_bf16 v[80:83], v[216:219], v[128:131], v[80:83]
    ds_read_b64_tr_b16 v[212:213], v233 offset:24576
    ds_read_b64_tr_b16 v[214:215], v233 offset:28672
    s_waitcnt lgkmcnt(12)
    v_mfma_f32_16x16x32_bf16 v[84:87], v[220:223], v[120:123], v[84:87]
    v_mfma_f32_16x16x32_bf16 v[88:91], v[220:223], v[124:127], v[88:91]
    v_mfma_f32_16x16x32_bf16 v[92:95], v[220:223], v[128:131], v[92:95]
    ds_read_b64_tr_b16 v[216:217], v234 offset:24576
    ds_read_b64_tr_b16 v[218:219], v234 offset:28672
    s_waitcnt lgkmcnt(12)
    v_mfma_f32_16x16x32_bf16 v[0:3], v[192:195], v[132:135], v[0:3]
    v_mfma_f32_16x16x32_bf16 v[4:7], v[192:195], v[136:139], v[4:7]
    v_mfma_f32_16x16x32_bf16 v[8:11], v[192:195], v[140:143], v[8:11]
    ds_read_b64_tr_b16 v[220:221], v235 offset:24576
    ds_read_b64_tr_b16 v[222:223], v235 offset:28672
    s_waitcnt lgkmcnt(12)
    v_mfma_f32_16x16x32_bf16 v[12:15], v[196:199], v[132:135], v[12:15]
    v_mfma_f32_16x16x32_bf16 v[16:19], v[196:199], v[136:139], v[16:19]
    v_mfma_f32_16x16x32_bf16 v[20:23], v[196:199], v[140:143], v[20:23]
    s_waitcnt lgkmcnt(10)
    v_mfma_f32_16x16x32_bf16 v[24:27], v[200:203], v[132:135], v[24:27]
    v_mfma_f32_16x16x32_bf16 v[28:31], v[200:203], v[136:139], v[28:31]
    v_mfma_f32_16x16x32_bf16 v[32:35], v[200:203], v[140:143], v[32:35]
    s_waitcnt lgkmcnt(8)
    v_mfma_f32_16x16x32_bf16 v[36:39], v[204:207], v[132:135], v[36:39]
    v_mfma_f32_16x16x32_bf16 v[40:43], v[204:207], v[136:139], v[40:43]
    v_mfma_f32_16x16x32_bf16 v[44:47], v[204:207], v[140:143], v[44:47]
    s_waitcnt lgkmcnt(6)
    v_mfma_f32_16x16x32_bf16 v[48:51], v[208:211], v[132:135], v[48:51]
    v_mfma_f32_16x16x32_bf16 v[52:55], v[208:211], v[136:139], v[52:55]
    v_mfma_f32_16x16x32_bf16 v[56:59], v[208:211], v[140:143], v[56:59]
    s_waitcnt lgkmcnt(4)
    v_mfma_f32_16x16x32_bf16 v[60:63], v[212:215], v[132:135], v[60:63]
    v_mfma_f32_16x16x32_bf16 v[64:67], v[212:215], v[136:139], v[64:67]
    v_mfma_f32_16x16x32_bf16 v[68:71], v[212:215], v[140:143], v[68:71]
    s_waitcnt lgkmcnt(2)
    v_mfma_f32_16x16x32_bf16 v[72:75], v[216:219], v[132:135], v[72:75]
    v_mfma_f32_16x16x32_bf16 v[76:79], v[216:219], v[136:139], v[76:79]
    v_mfma_f32_16x16x32_bf16 v[80:83], v[216:219], v[140:143], v[80:83]
    s_waitcnt lgkmcnt(0)
    v_mfma_f32_16x16x32_bf16 v[84:87], v[220:223], v[132:135], v[84:87]
    v_mfma_f32_16x16x32_bf16 v[88:91], v[220:223], v[136:139], v[88:91]
    v_mfma_f32_16x16x32_bf16 v[92:95], v[220:223], v[140:143], v[92:95]
    s_waitcnt vmcnt(20)
    s_barrier
    s_add_u32 m0, s29, 16384
    s_add_u32 s57, s58, 5
    s_and_b32 s57, s57, 7
    s_lshl_b32 s57, s57, 19
    s_add_u32 s32, s57, 0
    buffer_load_dwordx4 v251, s[16:19], s32 offen offset:0 lds
    s_add_u32 s32, s57, 64512
    buffer_load_dwordx4 v252, s[16:19], s32 offen offset:1024 lds
    s_add_u32 s32, s57, 129024
    buffer_load_dwordx4 v251, s[16:19], s32 offen offset:2048 lds
    s_add_u32 s32, s57, 193536
    buffer_load_dwordx4 v252, s[16:19], s32 offen offset:3072 lds
    s_add_u32 s57, s58, 5
    s_and_b32 s57, s57, 7
    s_lshl_b32 s57, s57, 7
    buffer_load_dwordx4 v[120:123], v253, s[20:23], s57 offen offset:0
    buffer_load_dwordx4 v[124:127], v254, s[20:23], s57 offen offset:0
    buffer_load_dwordx4 v[128:131], v255, s[20:23], s57 offen offset:0
    buffer_load_dwordx4 v[132:135], v253, s[20:23], s57 offen offset:64
    buffer_load_dwordx4 v[136:139], v254, s[20:23], s57 offen offset:64
    buffer_load_dwordx4 v[140:143], v255, s[20:23], s57 offen offset:64
    ds_read_b64_tr_b16 v[192:193], v228 offset:32768
    ds_read_b64_tr_b16 v[194:195], v228 offset:36864
    ds_read_b64_tr_b16 v[196:197], v229 offset:32768
    ds_read_b64_tr_b16 v[198:199], v229 offset:36864
    ds_read_b64_tr_b16 v[200:201], v230 offset:32768
    ds_read_b64_tr_b16 v[202:203], v230 offset:36864
    ds_read_b64_tr_b16 v[204:205], v231 offset:32768
    ds_read_b64_tr_b16 v[206:207], v231 offset:36864
    ds_read_b64_tr_b16 v[208:209], v232 offset:32768
    ds_read_b64_tr_b16 v[210:211], v232 offset:36864
    ds_read_b64_tr_b16 v[212:213], v233 offset:32768
    ds_read_b64_tr_b16 v[214:215], v233 offset:36864
    ds_read_b64_tr_b16 v[216:217], v234 offset:32768
    ds_read_b64_tr_b16 v[218:219], v234 offset:36864
    s_waitcnt lgkmcnt(12)
    v_mfma_f32_16x16x32_bf16 v[0:3], v[192:195], v[144:147], v[0:3]
    v_mfma_f32_16x16x32_bf16 v[4:7], v[192:195], v[148:151], v[4:7]
    v_mfma_f32_16x16x32_bf16 v[8:11], v[192:195], v[152:155], v[8:11]
    ds_read_b64_tr_b16 v[220:221], v235 offset:32768
    ds_read_b64_tr_b16 v[222:223], v235 offset:36864
    s_waitcnt lgkmcnt(12)
    v_mfma_f32_16x16x32_bf16 v[12:15], v[196:199], v[144:147], v[12:15]
    v_mfma_f32_16x16x32_bf16 v[16:19], v[196:199], v[148:151], v[16:19]
    v_mfma_f32_16x16x32_bf16 v[20:23], v[196:199], v[152:155], v[20:23]
    ds_read_b64_tr_b16 v[192:193], v228 offset:40960
    ds_read_b64_tr_b16 v[194:195], v228 offset:45056
    s_waitcnt lgkmcnt(12)
    v_mfma_f32_16x16x32_bf16 v[24:27], v[200:203], v[144:147], v[24:27]
    v_mfma_f32_16x16x32_bf16 v[28:31], v[200:203], v[148:151], v[28:31]
    v_mfma_f32_16x16x32_bf16 v[32:35], v[200:203], v[152:155], v[32:35]
    ds_read_b64_tr_b16 v[196:197], v229 offset:40960
    ds_read_b64_tr_b16 v[198:199], v229 offset:45056
    s_waitcnt lgkmcnt(12)
    v_mfma_f32_16x16x32_bf16 v[36:39], v[204:207], v[144:147], v[36:39]
    v_mfma_f32_16x16x32_bf16 v[40:43], v[204:207], v[148:151], v[40:43]
    v_mfma_f32_16x16x32_bf16 v[44:47], v[204:207], v[152:155], v[44:47]
    ds_read_b64_tr_b16 v[200:201], v230 offset:40960
    ds_read_b64_tr_b16 v[202:203], v230 offset:45056
    s_waitcnt lgkmcnt(12)
    v_mfma_f32_16x16x32_bf16 v[48:51], v[208:211], v[144:147], v[48:51]
    v_mfma_f32_16x16x32_bf16 v[52:55], v[208:211], v[148:151], v[52:55]
    v_mfma_f32_16x16x32_bf16 v[56:59], v[208:211], v[152:155], v[56:59]
    ds_read_b64_tr_b16 v[204:205], v231 offset:40960
    ds_read_b64_tr_b16 v[206:207], v231 offset:45056
    s_waitcnt lgkmcnt(12)
    v_mfma_f32_16x16x32_bf16 v[60:63], v[212:215], v[144:147], v[60:63]
    v_mfma_f32_16x16x32_bf16 v[64:67], v[212:215], v[148:151], v[64:67]
    v_mfma_f32_16x16x32_bf16 v[68:71], v[212:215], v[152:155], v[68:71]
    ds_read_b64_tr_b16 v[208:209], v232 offset:40960
    ds_read_b64_tr_b16 v[210:211], v232 offset:45056
    s_waitcnt lgkmcnt(12)
    v_mfma_f32_16x16x32_bf16 v[72:75], v[216:219], v[144:147], v[72:75]
    v_mfma_f32_16x16x32_bf16 v[76:79], v[216:219], v[148:151], v[76:79]
    v_mfma_f32_16x16x32_bf16 v[80:83], v[216:219], v[152:155], v[80:83]
    ds_read_b64_tr_b16 v[212:213], v233 offset:40960
    ds_read_b64_tr_b16 v[214:215], v233 offset:45056
    s_waitcnt lgkmcnt(12)
    v_mfma_f32_16x16x32_bf16 v[84:87], v[220:223], v[144:147], v[84:87]
    v_mfma_f32_16x16x32_bf16 v[88:91], v[220:223], v[148:151], v[88:91]
    v_mfma_f32_16x16x32_bf16 v[92:95], v[220:223], v[152:155], v[92:95]
    ds_read_b64_tr_b16 v[216:217], v234 offset:40960
    ds_read_b64_tr_b16 v[218:219], v234 offset:45056
    s_waitcnt lgkmcnt(12)
    v_mfma_f32_16x16x32_bf16 v[0:3], v[192:195], v[156:159], v[0:3]
    v_mfma_f32_16x16x32_bf16 v[4:7], v[192:195], v[160:163], v[4:7]
    v_mfma_f32_16x16x32_bf16 v[8:11], v[192:195], v[164:167], v[8:11]
    ds_read_b64_tr_b16 v[220:221], v235 offset:40960
    ds_read_b64_tr_b16 v[222:223], v235 offset:45056
    s_waitcnt lgkmcnt(12)
    v_mfma_f32_16x16x32_bf16 v[12:15], v[196:199], v[156:159], v[12:15]
    v_mfma_f32_16x16x32_bf16 v[16:19], v[196:199], v[160:163], v[16:19]
    v_mfma_f32_16x16x32_bf16 v[20:23], v[196:199], v[164:167], v[20:23]
    s_waitcnt lgkmcnt(10)
    v_mfma_f32_16x16x32_bf16 v[24:27], v[200:203], v[156:159], v[24:27]
    v_mfma_f32_16x16x32_bf16 v[28:31], v[200:203], v[160:163], v[28:31]
    v_mfma_f32_16x16x32_bf16 v[32:35], v[200:203], v[164:167], v[32:35]
    s_waitcnt lgkmcnt(8)
    v_mfma_f32_16x16x32_bf16 v[36:39], v[204:207], v[156:159], v[36:39]
    v_mfma_f32_16x16x32_bf16 v[40:43], v[204:207], v[160:163], v[40:43]
    v_mfma_f32_16x16x32_bf16 v[44:47], v[204:207], v[164:167], v[44:47]
    s_waitcnt lgkmcnt(6)
    v_mfma_f32_16x16x32_bf16 v[48:51], v[208:211], v[156:159], v[48:51]
    v_mfma_f32_16x16x32_bf16 v[52:55], v[208:211], v[160:163], v[52:55]
    v_mfma_f32_16x16x32_bf16 v[56:59], v[208:211], v[164:167], v[56:59]
    s_waitcnt lgkmcnt(4)
    v_mfma_f32_16x16x32_bf16 v[60:63], v[212:215], v[156:159], v[60:63]
    v_mfma_f32_16x16x32_bf16 v[64:67], v[212:215], v[160:163], v[64:67]
    v_mfma_f32_16x16x32_bf16 v[68:71], v[212:215], v[164:167], v[68:71]
    s_waitcnt lgkmcnt(2)
    v_mfma_f32_16x16x32_bf16 v[72:75], v[216:219], v[156:159], v[72:75]
    v_mfma_f32_16x16x32_bf16 v[76:79], v[216:219], v[160:163], v[76:79]
    v_mfma_f32_16x16x32_bf16 v[80:83], v[216:219], v[164:167], v[80:83]
    s_waitcnt lgkmcnt(0)
    v_mfma_f32_16x16x32_bf16 v[84:87], v[220:223], v[156:159], v[84:87]
    v_mfma_f32_16x16x32_bf16 v[88:91], v[220:223], v[160:163], v[88:91]
    v_mfma_f32_16x16x32_bf16 v[92:95], v[220:223], v[164:167], v[92:95]
    s_waitcnt vmcnt(20)
    s_barrier
    s_add_u32 m0, s29, 32768
    s_add_u32 s57, s58, 6
    s_and_b32 s57, s57, 7
    s_lshl_b32 s57, s57, 19
    s_add_u32 s32, s57, 0
    buffer_load_dwordx4 v251, s[16:19], s32 offen offset:0 lds
    s_add_u32 s32, s57, 64512
    buffer_load_dwordx4 v252, s[16:19], s32 offen offset:1024 lds
    s_add_u32 s32, s57, 129024
    buffer_load_dwordx4 v251, s[16:19], s32 offen offset:2048 lds
    s_add_u32 s32, s57, 193536
    buffer_load_dwordx4 v252, s[16:19], s32 offen offset:3072 lds
    s_add_u32 s57, s58, 6
    s_and_b32 s57, s57, 7
    s_lshl_b32 s57, s57, 7
    buffer_load_dwordx4 v[144:147], v253, s[20:23], s57 offen offset:0
    buffer_load_dwordx4 v[148:151], v254, s[20:23], s57 offen offset:0
    buffer_load_dwordx4 v[152:155], v255, s[20:23], s57 offen offset:0
    buffer_load_dwordx4 v[156:159], v253, s[20:23], s57 offen offset:64
    buffer_load_dwordx4 v[160:163], v254, s[20:23], s57 offen offset:64
    buffer_load_dwordx4 v[164:167], v255, s[20:23], s57 offen offset:64
    ds_read_b64_tr_b16 v[192:193], v228 offset:49152
    ds_read_b64_tr_b16 v[194:195], v228 offset:53248
    ds_read_b64_tr_b16 v[196:197], v229 offset:49152
    ds_read_b64_tr_b16 v[198:199], v229 offset:53248
    ds_read_b64_tr_b16 v[200:201], v230 offset:49152
    ds_read_b64_tr_b16 v[202:203], v230 offset:53248
    ds_read_b64_tr_b16 v[204:205], v231 offset:49152
    ds_read_b64_tr_b16 v[206:207], v231 offset:53248
    ds_read_b64_tr_b16 v[208:209], v232 offset:49152
    ds_read_b64_tr_b16 v[210:211], v232 offset:53248
    ds_read_b64_tr_b16 v[212:213], v233 offset:49152
    ds_read_b64_tr_b16 v[214:215], v233 offset:53248
    ds_read_b64_tr_b16 v[216:217], v234 offset:49152
    ds_read_b64_tr_b16 v[218:219], v234 offset:53248
    s_waitcnt lgkmcnt(12)
    v_mfma_f32_16x16x32_bf16 v[0:3], v[192:195], v[168:171], v[0:3]
    v_mfma_f32_16x16x32_bf16 v[4:7], v[192:195], v[172:175], v[4:7]
    v_mfma_f32_16x16x32_bf16 v[8:11], v[192:195], v[176:179], v[8:11]
    ds_read_b64_tr_b16 v[220:221], v235 offset:49152
    ds_read_b64_tr_b16 v[222:223], v235 offset:53248
    s_waitcnt lgkmcnt(12)
    v_mfma_f32_16x16x32_bf16 v[12:15], v[196:199], v[168:171], v[12:15]
    v_mfma_f32_16x16x32_bf16 v[16:19], v[196:199], v[172:175], v[16:19]
    v_mfma_f32_16x16x32_bf16 v[20:23], v[196:199], v[176:179], v[20:23]
    ds_read_b64_tr_b16 v[192:193], v228 offset:57344
    ds_read_b64_tr_b16 v[194:195], v228 offset:61440
    s_waitcnt lgkmcnt(12)
    v_mfma_f32_16x16x32_bf16 v[24:27], v[200:203], v[168:171], v[24:27]
    v_mfma_f32_16x16x32_bf16 v[28:31], v[200:203], v[172:175], v[28:31]
    v_mfma_f32_16x16x32_bf16 v[32:35], v[200:203], v[176:179], v[32:35]
    ds_read_b64_tr_b16 v[196:197], v229 offset:57344
    ds_read_b64_tr_b16 v[198:199], v229 offset:61440
    s_waitcnt lgkmcnt(12)
    v_mfma_f32_16x16x32_bf16 v[36:39], v[204:207], v[168:171], v[36:39]
    v_mfma_f32_16x16x32_bf16 v[40:43], v[204:207], v[172:175], v[40:43]
    v_mfma_f32_16x16x32_bf16 v[44:47], v[204:207], v[176:179], v[44:47]
    ds_read_b64_tr_b16 v[200:201], v230 offset:57344
    ds_read_b64_tr_b16 v[202:203], v230 offset:61440
    s_waitcnt lgkmcnt(12)
    v_mfma_f32_16x16x32_bf16 v[48:51], v[208:211], v[168:171], v[48:51]
    v_mfma_f32_16x16x32_bf16 v[52:55], v[208:211], v[172:175], v[52:55]
    v_mfma_f32_16x16x32_bf16 v[56:59], v[208:211], v[176:179], v[56:59]
    ds_read_b64_tr_b16 v[204:205], v231 offset:57344
    ds_read_b64_tr_b16 v[206:207], v231 offset:61440
    s_waitcnt lgkmcnt(12)
    v_mfma_f32_16x16x32_bf16 v[60:63], v[212:215], v[168:171], v[60:63]
    v_mfma_f32_16x16x32_bf16 v[64:67], v[212:215], v[172:175], v[64:67]
    v_mfma_f32_16x16x32_bf16 v[68:71], v[212:215], v[176:179], v[68:71]
    ds_read_b64_tr_b16 v[208:209], v232 offset:57344
    ds_read_b64_tr_b16 v[210:211], v232 offset:61440
    s_waitcnt lgkmcnt(12)
    v_mfma_f32_16x16x32_bf16 v[72:75], v[216:219], v[168:171], v[72:75]
    v_mfma_f32_16x16x32_bf16 v[76:79], v[216:219], v[172:175], v[76:79]
    v_mfma_f32_16x16x32_bf16 v[80:83], v[216:219], v[176:179], v[80:83]
    ds_read_b64_tr_b16 v[212:213], v233 offset:57344
    ds_read_b64_tr_b16 v[214:215], v233 offset:61440
    s_waitcnt lgkmcnt(12)
    v_mfma_f32_16x16x32_bf16 v[84:87], v[220:223], v[168:171], v[84:87]
    v_mfma_f32_16x16x32_bf16 v[88:91], v[220:223], v[172:175], v[88:91]
    v_mfma_f32_16x16x32_bf16 v[92:95], v[220:223], v[176:179], v[92:95]
    ds_read_b64_tr_b16 v[216:217], v234 offset:57344
    ds_read_b64_tr_b16 v[218:219], v234 offset:61440
    s_waitcnt lgkmcnt(12)
    v_mfma_f32_16x16x32_bf16 v[0:3], v[192:195], v[180:183], v[0:3]
    v_mfma_f32_16x16x32_bf16 v[4:7], v[192:195], v[184:187], v[4:7]
    v_mfma_f32_16x16x32_bf16 v[8:11], v[192:195], v[188:191], v[8:11]
    ds_read_b64_tr_b16 v[220:221], v235 offset:57344
    ds_read_b64_tr_b16 v[222:223], v235 offset:61440
    s_waitcnt lgkmcnt(12)
    v_mfma_f32_16x16x32_bf16 v[12:15], v[196:199], v[180:183], v[12:15]
    v_mfma_f32_16x16x32_bf16 v[16:19], v[196:199], v[184:187], v[16:19]
    v_mfma_f32_16x16x32_bf16 v[20:23], v[196:199], v[188:191], v[20:23]
    s_waitcnt lgkmcnt(10)
    v_mfma_f32_16x16x32_bf16 v[24:27], v[200:203], v[180:183], v[24:27]
    v_mfma_f32_16x16x32_bf16 v[28:31], v[200:203], v[184:187], v[28:31]
    v_mfma_f32_16x16x32_bf16 v[32:35], v[200:203], v[188:191], v[32:35]
    s_waitcnt lgkmcnt(8)
    v_mfma_f32_16x16x32_bf16 v[36:39], v[204:207], v[180:183], v[36:39]
    v_mfma_f32_16x16x32_bf16 v[40:43], v[204:207], v[184:187], v[40:43]
    v_mfma_f32_16x16x32_bf16 v[44:47], v[204:207], v[188:191], v[44:47]
    s_waitcnt lgkmcnt(6)
    v_mfma_f32_16x16x32_bf16 v[48:51], v[208:211], v[180:183], v[48:51]
    v_mfma_f32_16x16x32_bf16 v[52:55], v[208:211], v[184:187], v[52:55]
    v_mfma_f32_16x16x32_bf16 v[56:59], v[208:211], v[188:191], v[56:59]
    s_waitcnt lgkmcnt(4)
    v_mfma_f32_16x16x32_bf16 v[60:63], v[212:215], v[180:183], v[60:63]
    v_mfma_f32_16x16x32_bf16 v[64:67], v[212:215], v[184:187], v[64:67]
    v_mfma_f32_16x16x32_bf16 v[68:71], v[212:215], v[188:191], v[68:71]
    s_waitcnt lgkmcnt(2)
    v_mfma_f32_16x16x32_bf16 v[72:75], v[216:219], v[180:183], v[72:75]
    v_mfma_f32_16x16x32_bf16 v[76:79], v[216:219], v[184:187], v[76:79]
    v_mfma_f32_16x16x32_bf16 v[80:83], v[216:219], v[188:191], v[80:83]
    s_waitcnt lgkmcnt(0)
    v_mfma_f32_16x16x32_bf16 v[84:87], v[220:223], v[180:183], v[84:87]
    v_mfma_f32_16x16x32_bf16 v[88:91], v[220:223], v[184:187], v[88:91]
    v_mfma_f32_16x16x32_bf16 v[92:95], v[220:223], v[188:191], v[92:95]
    s_waitcnt vmcnt(20)
    s_barrier
    s_add_u32 m0, s29, 49152
    s_add_u32 s57, s58, 7
    s_and_b32 s57, s57, 7
    s_lshl_b32 s57, s57, 19
    s_add_u32 s32, s57, 0
    buffer_load_dwordx4 v251, s[16:19], s32 offen offset:0 lds
    s_add_u32 s32, s57, 64512
    buffer_load_dwordx4 v252, s[16:19], s32 offen offset:1024 lds
    s_add_u32 s32, s57, 129024
    buffer_load_dwordx4 v251, s[16:19], s32 offen offset:2048 lds
    s_add_u32 s32, s57, 193536
    buffer_load_dwordx4 v252, s[16:19], s32 offen offset:3072 lds
    s_add_u32 s57, s58, 7
    s_and_b32 s57, s57, 7
    s_lshl_b32 s57, s57, 7
    buffer_load_dwordx4 v[168:171], v253, s[20:23], s57 offen offset:0
    buffer_load_dwordx4 v[172:175], v254, s[20:23], s57 offen offset:0
    buffer_load_dwordx4 v[176:179], v255, s[20:23], s57 offen offset:0
    buffer_load_dwordx4 v[180:183], v253, s[20:23], s57 offen offset:64
    buffer_load_dwordx4 v[184:187], v254, s[20:23], s57 offen offset:64
    buffer_load_dwordx4 v[188:191], v255, s[20:23], s57 offen offset:64
    ds_read_b64_tr_b16 v[192:193], v228 offset:0
    ds_read_b64_tr_b16 v[194:195], v228 offset:4096
    ds_read_b64_tr_b16 v[196:197], v229 offset:0
    ds_read_b64_tr_b16 v[198:199], v229 offset:4096
    ds_read_b64_tr_b16 v[200:201], v230 offset:0
    ds_read_b64_tr_b16 v[202:203], v230 offset:4096
    ds_read_b64_tr_b16 v[204:205], v231 offset:0
    ds_read_b64_tr_b16 v[206:207], v231 offset:4096
    ds_read_b64_tr_b16 v[208:209], v232 offset:0
    ds_read_b64_tr_b16 v[210:211], v232 offset:4096
    ds_read_b64_tr_b16 v[212:213], v233 offset:0
    ds_read_b64_tr_b16 v[214:215], v233 offset:4096
    ds_read_b64_tr_b16 v[216:217], v234 offset:0
    ds_read_b64_tr_b16 v[218:219], v234 offset:4096
    s_waitcnt lgkmcnt(12)
    v_mfma_f32_16x16x32_bf16 v[0:3], v[192:195], v[96:99], v[0:3]
    v_mfma_f32_16x16x32_bf16 v[4:7], v[192:195], v[100:103], v[4:7]
    v_mfma_f32_16x16x32_bf16 v[8:11], v[192:195], v[104:107], v[8:11]
    ds_read_b64_tr_b16 v[220:221], v235 offset:0
    ds_read_b64_tr_b16 v[222:223], v235 offset:4096
    s_waitcnt lgkmcnt(12)
    v_mfma_f32_16x16x32_bf16 v[12:15], v[196:199], v[96:99], v[12:15]
    v_mfma_f32_16x16x32_bf16 v[16:19], v[196:199], v[100:103], v[16:19]
    v_mfma_f32_16x16x32_bf16 v[20:23], v[196:199], v[104:107], v[20:23]
    ds_read_b64_tr_b16 v[192:193], v228 offset:8192
    ds_read_b64_tr_b16 v[194:195], v228 offset:12288
    s_waitcnt lgkmcnt(12)
    v_mfma_f32_16x16x32_bf16 v[24:27], v[200:203], v[96:99], v[24:27]
    v_mfma_f32_16x16x32_bf16 v[28:31], v[200:203], v[100:103], v[28:31]
    v_mfma_f32_16x16x32_bf16 v[32:35], v[200:203], v[104:107], v[32:35]
    ds_read_b64_tr_b16 v[196:197], v229 offset:8192
    ds_read_b64_tr_b16 v[198:199], v229 offset:12288
    s_waitcnt lgkmcnt(12)
    v_mfma_f32_16x16x32_bf16 v[36:39], v[204:207], v[96:99], v[36:39]
    v_mfma_f32_16x16x32_bf16 v[40:43], v[204:207], v[100:103], v[40:43]
    v_mfma_f32_16x16x32_bf16 v[44:47], v[204:207], v[104:107], v[44:47]
    ds_read_b64_tr_b16 v[200:201], v230 offset:8192
    ds_read_b64_tr_b16 v[202:203], v230 offset:12288
    s_waitcnt lgkmcnt(12)
    v_mfma_f32_16x16x32_bf16 v[48:51], v[208:211], v[96:99], v[48:51]
    v_mfma_f32_16x16x32_bf16 v[52:55], v[208:211], v[100:103], v[52:55]
    v_mfma_f32_16x16x32_bf16 v[56:59], v[208:211], v[104:107], v[56:59]
    ds_read_b64_tr_b16 v[204:205], v231 offset:8192
    ds_read_b64_tr_b16 v[206:207], v231 offset:12288
    s_waitcnt lgkmcnt(12)
    v_mfma_f32_16x16x32_bf16 v[60:63], v[212:215], v[96:99], v[60:63]
    v_mfma_f32_16x16x32_bf16 v[64:67], v[212:215], v[100:103], v[64:67]
    v_mfma_f32_16x16x32_bf16 v[68:71], v[212:215], v[104:107], v[68:71]
    ds_read_b64_tr_b16 v[208:209], v232 offset:8192
    ds_read_b64_tr_b16 v[210:211], v232 offset:12288
    s_waitcnt lgkmcnt(12)
    v_mfma_f32_16x16x32_bf16 v[72:75], v[216:219], v[96:99], v[72:75]
    v_mfma_f32_16x16x32_bf16 v[76:79], v[216:219], v[100:103], v[76:79]
    v_mfma_f32_16x16x32_bf16 v[80:83], v[216:219], v[104:107], v[80:83]
    ds_read_b64_tr_b16 v[212:213], v233 offset:8192
    ds_read_b64_tr_b16 v[214:215], v233 offset:12288
    s_waitcnt lgkmcnt(12)
    v_mfma_f32_16x16x32_bf16 v[84:87], v[220:223], v[96:99], v[84:87]
    v_mfma_f32_16x16x32_bf16 v[88:91], v[220:223], v[100:103], v[88:91]
    v_mfma_f32_16x16x32_bf16 v[92:95], v[220:223], v[104:107], v[92:95]
    ds_read_b64_tr_b16 v[216:217], v234 offset:8192
    ds_read_b64_tr_b16 v[218:219], v234 offset:12288
    s_waitcnt lgkmcnt(12)
    v_mfma_f32_16x16x32_bf16 v[0:3], v[192:195], v[108:111], v[0:3]
    v_mfma_f32_16x16x32_bf16 v[4:7], v[192:195], v[112:115], v[4:7]
    v_mfma_f32_16x16x32_bf16 v[8:11], v[192:195], v[116:119], v[8:11]
    ds_read_b64_tr_b16 v[220:221], v235 offset:8192
    ds_read_b64_tr_b16 v[222:223], v235 offset:12288
    s_waitcnt lgkmcnt(12)
    v_mfma_f32_16x16x32_bf16 v[12:15], v[196:199], v[108:111], v[12:15]
    v_mfma_f32_16x16x32_bf16 v[16:19], v[196:199], v[112:115], v[16:19]
    v_mfma_f32_16x16x32_bf16 v[20:23], v[196:199], v[116:119], v[20:23]
    s_waitcnt lgkmcnt(10)
    v_mfma_f32_16x16x32_bf16 v[24:27], v[200:203], v[108:111], v[24:27]
    v_mfma_f32_16x16x32_bf16 v[28:31], v[200:203], v[112:115], v[28:31]
    v_mfma_f32_16x16x32_bf16 v[32:35], v[200:203], v[116:119], v[32:35]
    s_waitcnt lgkmcnt(8)
    v_mfma_f32_16x16x32_bf16 v[36:39], v[204:207], v[108:111], v[36:39]
    v_mfma_f32_16x16x32_bf16 v[40:43], v[204:207], v[112:115], v[40:43]
    v_mfma_f32_16x16x32_bf16 v[44:47], v[204:207], v[116:119], v[44:47]
    s_waitcnt lgkmcnt(6)
    v_mfma_f32_16x16x32_bf16 v[48:51], v[208:211], v[108:111], v[48:51]
    v_mfma_f32_16x16x32_bf16 v[52:55], v[208:211], v[112:115], v[52:55]
    v_mfma_f32_16x16x32_bf16 v[56:59], v[208:211], v[116:119], v[56:59]
    s_waitcnt lgkmcnt(4)
    v_mfma_f32_16x16x32_bf16 v[60:63], v[212:215], v[108:111], v[60:63]
    v_mfma_f32_16x16x32_bf16 v[64:67], v[212:215], v[112:115], v[64:67]
    v_mfma_f32_16x16x32_bf16 v[68:71], v[212:215], v[116:119], v[68:71]
    s_waitcnt lgkmcnt(2)
    v_mfma_f32_16x16x32_bf16 v[72:75], v[216:219], v[108:111], v[72:75]
    v_mfma_f32_16x16x32_bf16 v[76:79], v[216:219], v[112:115], v[76:79]
    v_mfma_f32_16x16x32_bf16 v[80:83], v[216:219], v[116:119], v[80:83]
    s_waitcnt lgkmcnt(0)
    v_mfma_f32_16x16x32_bf16 v[84:87], v[220:223], v[108:111], v[84:87]
    v_mfma_f32_16x16x32_bf16 v[88:91], v[220:223], v[112:115], v[88:91]
    v_mfma_f32_16x16x32_bf16 v[92:95], v[220:223], v[116:119], v[92:95]
    s_waitcnt vmcnt(20)
    s_barrier
    s_add_u32 m0, s29, 0
    s_add_u32 s32, s35, 0
    s_and_b32 s32, s32, 15
    s_lshl_b32 s32, s32, 14
    buffer_load_dwordx4 v236, s[8:11], s32 offen offset:0 nt lds
    buffer_load_dwordx4 v237, s[8:11], s32 offen offset:1024 nt lds
    buffer_load_dwordx4 v236, s[8:11], s32 offen offset:2048 nt lds
    buffer_load_dwordx4 v237, s[8:11], s32 offen offset:3072 nt lds
    ds_read_b64_tr_b16 v[192:193], v228 offset:16384
    ds_read_b64_tr_b16 v[194:195], v228 offset:20480
    ds_read_b64_tr_b16 v[196:197], v229 offset:16384
    ds_read_b64_tr_b16 v[198:199], v229 offset:20480
    ds_read_b64_tr_b16 v[200:201], v230 offset:16384
    ds_read_b64_tr_b16 v[202:203], v230 offset:20480
    ds_read_b64_tr_b16 v[204:205], v231 offset:16384
    ds_read_b64_tr_b16 v[206:207], v231 offset:20480
    ds_read_b64_tr_b16 v[208:209], v232 offset:16384
    ds_read_b64_tr_b16 v[210:211], v232 offset:20480
    ds_read_b64_tr_b16 v[212:213], v233 offset:16384
    ds_read_b64_tr_b16 v[214:215], v233 offset:20480
    ds_read_b64_tr_b16 v[216:217], v234 offset:16384
    ds_read_b64_tr_b16 v[218:219], v234 offset:20480
    s_waitcnt lgkmcnt(12)
    v_mfma_f32_16x16x32_bf16 v[0:3], v[192:195], v[120:123], v[0:3]
    v_mfma_f32_16x16x32_bf16 v[4:7], v[192:195], v[124:127], v[4:7]
    v_mfma_f32_16x16x32_bf16 v[8:11], v[192:195], v[128:131], v[8:11]
    ds_read_b64_tr_b16 v[220:221], v235 offset:16384
    ds_read_b64_tr_b16 v[222:223], v235 offset:20480
    s_waitcnt lgkmcnt(12)
    v_mfma_f32_16x16x32_bf16 v[12:15], v[196:199], v[120:123], v[12:15]
    v_mfma_f32_16x16x32_bf16 v[16:19], v[196:199], v[124:127], v[16:19]
    v_mfma_f32_16x16x32_bf16 v[20:23], v[196:199], v[128:131], v[20:23]
    ds_read_b64_tr_b16 v[192:193], v228 offset:24576
    ds_read_b64_tr_b16 v[194:195], v228 offset:28672
    s_waitcnt lgkmcnt(12)
    v_mfma_f32_16x16x32_bf16 v[24:27], v[200:203], v[120:123], v[24:27]
    v_mfma_f32_16x16x32_bf16 v[28:31], v[200:203], v[124:127], v[28:31]
    v_mfma_f32_16x16x32_bf16 v[32:35], v[200:203], v[128:131], v[32:35]
    ds_read_b64_tr_b16 v[196:197], v229 offset:24576
    ds_read_b64_tr_b16 v[198:199], v229 offset:28672
    s_waitcnt lgkmcnt(12)
    v_mfma_f32_16x16x32_bf16 v[36:39], v[204:207], v[120:123], v[36:39]
    v_mfma_f32_16x16x32_bf16 v[40:43], v[204:207], v[124:127], v[40:43]
    v_mfma_f32_16x16x32_bf16 v[44:47], v[204:207], v[128:131], v[44:47]
    ds_read_b64_tr_b16 v[200:201], v230 offset:24576
    ds_read_b64_tr_b16 v[202:203], v230 offset:28672
    s_waitcnt lgkmcnt(12)
    v_mfma_f32_16x16x32_bf16 v[48:51], v[208:211], v[120:123], v[48:51]
    v_mfma_f32_16x16x32_bf16 v[52:55], v[208:211], v[124:127], v[52:55]
    v_mfma_f32_16x16x32_bf16 v[56:59], v[208:211], v[128:131], v[56:59]
    ds_read_b64_tr_b16 v[204:205], v231 offset:24576
    ds_read_b64_tr_b16 v[206:207], v231 offset:28672
    s_waitcnt lgkmcnt(12)
    v_mfma_f32_16x16x32_bf16 v[60:63], v[212:215], v[120:123], v[60:63]
    v_mfma_f32_16x16x32_bf16 v[64:67], v[212:215], v[124:127], v[64:67]
    v_mfma_f32_16x16x32_bf16 v[68:71], v[212:215], v[128:131], v[68:71]
    ds_read_b64_tr_b16 v[208:209], v232 offset:24576
    ds_read_b64_tr_b16 v[210:211], v232 offset:28672
    s_waitcnt lgkmcnt(12)
    v_mfma_f32_16x16x32_bf16 v[72:75], v[216:219], v[120:123], v[72:75]
    v_mfma_f32_16x16x32_bf16 v[76:79], v[216:219], v[124:127], v[76:79]
    v_mfma_f32_16x16x32_bf16 v[80:83], v[216:219], v[128:131], v[80:83]
    ds_read_b64_tr_b16 v[212:213], v233 offset:24576
    ds_read_b64_tr_b16 v[214:215], v233 offset:28672
    s_waitcnt lgkmcnt(12)
    v_mfma_f32_16x16x32_bf16 v[84:87], v[220:223], v[120:123], v[84:87]
    v_mfma_f32_16x16x32_bf16 v[88:91], v[220:223], v[124:127], v[88:91]
    v_mfma_f32_16x16x32_bf16 v[92:95], v[220:223], v[128:131], v[92:95]
    ds_read_b64_tr_b16 v[216:217], v234 offset:24576
    ds_read_b64_tr_b16 v[218:219], v234 offset:28672
    s_waitcnt lgkmcnt(12)
    v_mfma_f32_16x16x32_bf16 v[0:3], v[192:195], v[132:135], v[0:3]
    v_mfma_f32_16x16x32_bf16 v[4:7], v[192:195], v[136:139], v[4:7]
    v_mfma_f32_16x16x32_bf16 v[8:11], v[192:195], v[140:143], v[8:11]
    ds_read_b64_tr_b16 v[220:221], v235 offset:24576
    ds_read_b64_tr_b16 v[222:223], v235 offset:28672
    s_waitcnt lgkmcnt(12)
    v_mfma_f32_16x16x32_bf16 v[12:15], v[196:199], v[132:135], v[12:15]
    v_mfma_f32_16x16x32_bf16 v[16:19], v[196:199], v[136:139], v[16:19]
    v_mfma_f32_16x16x32_bf16 v[20:23], v[196:199], v[140:143], v[20:23]
    s_waitcnt lgkmcnt(10)
    v_mfma_f32_16x16x32_bf16 v[24:27], v[200:203], v[132:135], v[24:27]
    v_mfma_f32_16x16x32_bf16 v[28:31], v[200:203], v[136:139], v[28:31]
    v_mfma_f32_16x16x32_bf16 v[32:35], v[200:203], v[140:143], v[32:35]
    s_waitcnt lgkmcnt(8)
    v_mfma_f32_16x16x32_bf16 v[36:39], v[204:207], v[132:135], v[36:39]
    v_mfma_f32_16x16x32_bf16 v[40:43], v[204:207], v[136:139], v[40:43]
    v_mfma_f32_16x16x32_bf16 v[44:47], v[204:207], v[140:143], v[44:47]
    s_waitcnt lgkmcnt(6)
    v_mfma_f32_16x16x32_bf16 v[48:51], v[208:211], v[132:135], v[48:51]
    v_mfma_f32_16x16x32_bf16 v[52:55], v[208:211], v[136:139], v[52:55]
    v_mfma_f32_16x16x32_bf16 v[56:59], v[208:211], v[140:143], v[56:59]
    s_waitcnt lgkmcnt(4)
    v_mfma_f32_16x16x32_bf16 v[60:63], v[212:215], v[132:135], v[60:63]
    v_mfma_f32_16x16x32_bf16 v[64:67], v[212:215], v[136:139], v[64:67]
    v_mfma_f32_16x16x32_bf16 v[68:71], v[212:215], v[140:143], v[68:71]
    s_waitcnt lgkmcnt(2)
    v_mfma_f32_16x16x32_bf16 v[72:75], v[216:219], v[132:135], v[72:75]
    v_mfma_f32_16x16x32_bf16 v[76:79], v[216:219], v[136:139], v[76:79]
    v_mfma_f32_16x16x32_bf16 v[80:83], v[216:219], v[140:143], v[80:83]
    s_waitcnt lgkmcnt(0)
    v_mfma_f32_16x16x32_bf16 v[84:87], v[220:223], v[132:135], v[84:87]
    v_mfma_f32_16x16x32_bf16 v[88:91], v[220:223], v[136:139], v[88:91]
    v_mfma_f32_16x16x32_bf16 v[92:95], v[220:223], v[140:143], v[92:95]
    s_waitcnt vmcnt(14)
    s_barrier
    s_add_u32 m0, s29, 16384
    s_add_u32 s32, s35, 0
    s_and_b32 s32, s32, 15
    s_lshl_b32 s32, s32, 14
    buffer_load_dwordx4 v236, s[12:15], s32 offen offset:0 nt lds
    buffer_load_dwordx4 v237, s[12:15], s32 offen offset:1024 nt lds
    buffer_load_dwordx4 v236, s[12:15], s32 offen offset:2048 nt lds
    buffer_load_dwordx4 v237, s[12:15], s32 offen offset:3072 nt lds
    ds_read_b64_tr_b16 v[192:193], v228 offset:32768
    ds_read_b64_tr_b16 v[194:195], v228 offset:36864
    ds_read_b64_tr_b16 v[196:197], v229 offset:32768
    ds_read_b64_tr_b16 v[198:199], v229 offset:36864
    ds_read_b64_tr_b16 v[200:201], v230 offset:32768
    ds_read_b64_tr_b16 v[202:203], v230 offset:36864
    ds_read_b64_tr_b16 v[204:205], v231 offset:32768
    ds_read_b64_tr_b16 v[206:207], v231 offset:36864
    ds_read_b64_tr_b16 v[208:209], v232 offset:32768
    ds_read_b64_tr_b16 v[210:211], v232 offset:36864
    ds_read_b64_tr_b16 v[212:213], v233 offset:32768
    ds_read_b64_tr_b16 v[214:215], v233 offset:36864
    ds_read_b64_tr_b16 v[216:217], v234 offset:32768
    ds_read_b64_tr_b16 v[218:219], v234 offset:36864
    s_waitcnt lgkmcnt(12)
    v_mfma_f32_16x16x32_bf16 v[0:3], v[192:195], v[144:147], v[0:3]
    v_mfma_f32_16x16x32_bf16 v[4:7], v[192:195], v[148:151], v[4:7]
    v_mfma_f32_16x16x32_bf16 v[8:11], v[192:195], v[152:155], v[8:11]
    ds_read_b64_tr_b16 v[220:221], v235 offset:32768
    ds_read_b64_tr_b16 v[222:223], v235 offset:36864
    s_waitcnt lgkmcnt(12)
    v_mfma_f32_16x16x32_bf16 v[12:15], v[196:199], v[144:147], v[12:15]
    v_mfma_f32_16x16x32_bf16 v[16:19], v[196:199], v[148:151], v[16:19]
    v_mfma_f32_16x16x32_bf16 v[20:23], v[196:199], v[152:155], v[20:23]
    ds_read_b64_tr_b16 v[192:193], v228 offset:40960
    ds_read_b64_tr_b16 v[194:195], v228 offset:45056
    s_waitcnt lgkmcnt(12)
    v_mfma_f32_16x16x32_bf16 v[24:27], v[200:203], v[144:147], v[24:27]
    v_mfma_f32_16x16x32_bf16 v[28:31], v[200:203], v[148:151], v[28:31]
    v_mfma_f32_16x16x32_bf16 v[32:35], v[200:203], v[152:155], v[32:35]
    ds_read_b64_tr_b16 v[196:197], v229 offset:40960
    ds_read_b64_tr_b16 v[198:199], v229 offset:45056
    s_waitcnt lgkmcnt(12)
    v_mfma_f32_16x16x32_bf16 v[36:39], v[204:207], v[144:147], v[36:39]
    v_mfma_f32_16x16x32_bf16 v[40:43], v[204:207], v[148:151], v[40:43]
    v_mfma_f32_16x16x32_bf16 v[44:47], v[204:207], v[152:155], v[44:47]
    ds_read_b64_tr_b16 v[200:201], v230 offset:40960
    ds_read_b64_tr_b16 v[202:203], v230 offset:45056
    s_waitcnt lgkmcnt(12)
    v_mfma_f32_16x16x32_bf16 v[48:51], v[208:211], v[144:147], v[48:51]
    v_mfma_f32_16x16x32_bf16 v[52:55], v[208:211], v[148:151], v[52:55]
    v_mfma_f32_16x16x32_bf16 v[56:59], v[208:211], v[152:155], v[56:59]
    ds_read_b64_tr_b16 v[204:205], v231 offset:40960
    ds_read_b64_tr_b16 v[206:207], v231 offset:45056
    s_waitcnt lgkmcnt(12)
    v_mfma_f32_16x16x32_bf16 v[60:63], v[212:215], v[144:147], v[60:63]
    v_mfma_f32_16x16x32_bf16 v[64:67], v[212:215], v[148:151], v[64:67]
    v_mfma_f32_16x16x32_bf16 v[68:71], v[212:215], v[152:155], v[68:71]
    ds_read_b64_tr_b16 v[208:209], v232 offset:40960
    ds_read_b64_tr_b16 v[210:211], v232 offset:45056
    s_waitcnt lgkmcnt(12)
    v_mfma_f32_16x16x32_bf16 v[72:75], v[216:219], v[144:147], v[72:75]
    v_mfma_f32_16x16x32_bf16 v[76:79], v[216:219], v[148:151], v[76:79]
    v_mfma_f32_16x16x32_bf16 v[80:83], v[216:219], v[152:155], v[80:83]
    ds_read_b64_tr_b16 v[212:213], v233 offset:40960
    ds_read_b64_tr_b16 v[214:215], v233 offset:45056
    s_waitcnt lgkmcnt(12)
    v_mfma_f32_16x16x32_bf16 v[84:87], v[220:223], v[144:147], v[84:87]
    v_mfma_f32_16x16x32_bf16 v[88:91], v[220:223], v[148:151], v[88:91]
    v_mfma_f32_16x16x32_bf16 v[92:95], v[220:223], v[152:155], v[92:95]
    ds_read_b64_tr_b16 v[216:217], v234 offset:40960
    ds_read_b64_tr_b16 v[218:219], v234 offset:45056
    s_waitcnt lgkmcnt(12)
    v_mfma_f32_16x16x32_bf16 v[0:3], v[192:195], v[156:159], v[0:3]
    v_mfma_f32_16x16x32_bf16 v[4:7], v[192:195], v[160:163], v[4:7]
    v_mfma_f32_16x16x32_bf16 v[8:11], v[192:195], v[164:167], v[8:11]
    ds_read_b64_tr_b16 v[220:221], v235 offset:40960
    ds_read_b64_tr_b16 v[222:223], v235 offset:45056
    s_waitcnt lgkmcnt(12)
    v_mfma_f32_16x16x32_bf16 v[12:15], v[196:199], v[156:159], v[12:15]
    v_mfma_f32_16x16x32_bf16 v[16:19], v[196:199], v[160:163], v[16:19]
    v_mfma_f32_16x16x32_bf16 v[20:23], v[196:199], v[164:167], v[20:23]
    s_waitcnt lgkmcnt(10)
    v_mfma_f32_16x16x32_bf16 v[24:27], v[200:203], v[156:159], v[24:27]
    v_mfma_f32_16x16x32_bf16 v[28:31], v[200:203], v[160:163], v[28:31]
    v_mfma_f32_16x16x32_bf16 v[32:35], v[200:203], v[164:167], v[32:35]
    s_waitcnt lgkmcnt(8)
    v_mfma_f32_16x16x32_bf16 v[36:39], v[204:207], v[156:159], v[36:39]
    v_mfma_f32_16x16x32_bf16 v[40:43], v[204:207], v[160:163], v[40:43]
    v_mfma_f32_16x16x32_bf16 v[44:47], v[204:207], v[164:167], v[44:47]
    s_waitcnt lgkmcnt(6)
    v_mfma_f32_16x16x32_bf16 v[48:51], v[208:211], v[156:159], v[48:51]
    v_mfma_f32_16x16x32_bf16 v[52:55], v[208:211], v[160:163], v[52:55]
    v_mfma_f32_16x16x32_bf16 v[56:59], v[208:211], v[164:167], v[56:59]
    s_waitcnt lgkmcnt(4)
    v_mfma_f32_16x16x32_bf16 v[60:63], v[212:215], v[156:159], v[60:63]
    v_mfma_f32_16x16x32_bf16 v[64:67], v[212:215], v[160:163], v[64:67]
    v_mfma_f32_16x16x32_bf16 v[68:71], v[212:215], v[164:167], v[68:71]
    s_waitcnt lgkmcnt(2)
    v_mfma_f32_16x16x32_bf16 v[72:75], v[216:219], v[156:159], v[72:75]
    v_mfma_f32_16x16x32_bf16 v[76:79], v[216:219], v[160:163], v[76:79]
    v_mfma_f32_16x16x32_bf16 v[80:83], v[216:219], v[164:167], v[80:83]
    s_waitcnt lgkmcnt(0)
    v_mfma_f32_16x16x32_bf16 v[84:87], v[220:223], v[156:159], v[84:87]
    v_mfma_f32_16x16x32_bf16 v[88:91], v[220:223], v[160:163], v[88:91]
    v_mfma_f32_16x16x32_bf16 v[92:95], v[220:223], v[164:167], v[92:95]
    s_waitcnt vmcnt(8)
    s_barrier
    s_add_u32 m0, s29, 32768
    s_add_u32 s32, s35, 1
    s_and_b32 s32, s32, 15
    s_lshl_b32 s32, s32, 14
    buffer_load_dwordx4 v236, s[8:11], s32 offen offset:0 nt lds
    buffer_load_dwordx4 v237, s[8:11], s32 offen offset:1024 nt lds
    buffer_load_dwordx4 v236, s[8:11], s32 offen offset:2048 nt lds
    buffer_load_dwordx4 v237, s[8:11], s32 offen offset:3072 nt lds
    ds_read_b64_tr_b16 v[192:193], v228 offset:49152
    ds_read_b64_tr_b16 v[194:195], v228 offset:53248
    ds_read_b64_tr_b16 v[196:197], v229 offset:49152
    ds_read_b64_tr_b16 v[198:199], v229 offset:53248
    ds_read_b64_tr_b16 v[200:201], v230 offset:49152
    ds_read_b64_tr_b16 v[202:203], v230 offset:53248
    ds_read_b64_tr_b16 v[204:205], v231 offset:49152
    ds_read_b64_tr_b16 v[206:207], v231 offset:53248
    ds_read_b64_tr_b16 v[208:209], v232 offset:49152
    ds_read_b64_tr_b16 v[210:211], v232 offset:53248
    ds_read_b64_tr_b16 v[212:213], v233 offset:49152
    ds_read_b64_tr_b16 v[214:215], v233 offset:53248
    ds_read_b64_tr_b16 v[216:217], v234 offset:49152
    ds_read_b64_tr_b16 v[218:219], v234 offset:53248
    s_waitcnt lgkmcnt(12)
    v_mfma_f32_16x16x32_bf16 v[0:3], v[192:195], v[168:171], v[0:3]
    v_mfma_f32_16x16x32_bf16 v[4:7], v[192:195], v[172:175], v[4:7]
    v_mfma_f32_16x16x32_bf16 v[8:11], v[192:195], v[176:179], v[8:11]
    ds_read_b64_tr_b16 v[220:221], v235 offset:49152
    ds_read_b64_tr_b16 v[222:223], v235 offset:53248
    s_waitcnt lgkmcnt(12)
    v_mfma_f32_16x16x32_bf16 v[12:15], v[196:199], v[168:171], v[12:15]
    v_mfma_f32_16x16x32_bf16 v[16:19], v[196:199], v[172:175], v[16:19]
    v_mfma_f32_16x16x32_bf16 v[20:23], v[196:199], v[176:179], v[20:23]
    ds_read_b64_tr_b16 v[192:193], v228 offset:57344
    ds_read_b64_tr_b16 v[194:195], v228 offset:61440
    s_waitcnt lgkmcnt(12)
    v_mfma_f32_16x16x32_bf16 v[24:27], v[200:203], v[168:171], v[24:27]
    v_mfma_f32_16x16x32_bf16 v[28:31], v[200:203], v[172:175], v[28:31]
    v_mfma_f32_16x16x32_bf16 v[32:35], v[200:203], v[176:179], v[32:35]
    ds_read_b64_tr_b16 v[196:197], v229 offset:57344
    ds_read_b64_tr_b16 v[198:199], v229 offset:61440
    s_waitcnt lgkmcnt(12)
    v_mfma_f32_16x16x32_bf16 v[36:39], v[204:207], v[168:171], v[36:39]
    v_mfma_f32_16x16x32_bf16 v[40:43], v[204:207], v[172:175], v[40:43]
    v_mfma_f32_16x16x32_bf16 v[44:47], v[204:207], v[176:179], v[44:47]
    ds_read_b64_tr_b16 v[200:201], v230 offset:57344
    ds_read_b64_tr_b16 v[202:203], v230 offset:61440
    s_waitcnt lgkmcnt(12)
    v_mfma_f32_16x16x32_bf16 v[48:51], v[208:211], v[168:171], v[48:51]
    v_mfma_f32_16x16x32_bf16 v[52:55], v[208:211], v[172:175], v[52:55]
    v_mfma_f32_16x16x32_bf16 v[56:59], v[208:211], v[176:179], v[56:59]
    ds_read_b64_tr_b16 v[204:205], v231 offset:57344
    ds_read_b64_tr_b16 v[206:207], v231 offset:61440
    s_waitcnt lgkmcnt(12)
    v_mfma_f32_16x16x32_bf16 v[60:63], v[212:215], v[168:171], v[60:63]
    v_mfma_f32_16x16x32_bf16 v[64:67], v[212:215], v[172:175], v[64:67]
    v_mfma_f32_16x16x32_bf16 v[68:71], v[212:215], v[176:179], v[68:71]
    ds_read_b64_tr_b16 v[208:209], v232 offset:57344
    ds_read_b64_tr_b16 v[210:211], v232 offset:61440
    s_waitcnt lgkmcnt(12)
    v_mfma_f32_16x16x32_bf16 v[72:75], v[216:219], v[168:171], v[72:75]
    v_mfma_f32_16x16x32_bf16 v[76:79], v[216:219], v[172:175], v[76:79]
    v_mfma_f32_16x16x32_bf16 v[80:83], v[216:219], v[176:179], v[80:83]
    ds_read_b64_tr_b16 v[212:213], v233 offset:57344
    ds_read_b64_tr_b16 v[214:215], v233 offset:61440
    s_waitcnt lgkmcnt(12)
    v_mfma_f32_16x16x32_bf16 v[84:87], v[220:223], v[168:171], v[84:87]
    v_mfma_f32_16x16x32_bf16 v[88:91], v[220:223], v[172:175], v[88:91]
    v_mfma_f32_16x16x32_bf16 v[92:95], v[220:223], v[176:179], v[92:95]
    ds_read_b64_tr_b16 v[216:217], v234 offset:57344
    ds_read_b64_tr_b16 v[218:219], v234 offset:61440
    s_waitcnt lgkmcnt(12)
    v_mfma_f32_16x16x32_bf16 v[0:3], v[192:195], v[180:183], v[0:3]
    v_mfma_f32_16x16x32_bf16 v[4:7], v[192:195], v[184:187], v[4:7]
    v_mfma_f32_16x16x32_bf16 v[8:11], v[192:195], v[188:191], v[8:11]
    ds_read_b64_tr_b16 v[220:221], v235 offset:57344
    ds_read_b64_tr_b16 v[222:223], v235 offset:61440
    s_waitcnt lgkmcnt(12)
    v_mfma_f32_16x16x32_bf16 v[12:15], v[196:199], v[180:183], v[12:15]
    v_mfma_f32_16x16x32_bf16 v[16:19], v[196:199], v[184:187], v[16:19]
    v_mfma_f32_16x16x32_bf16 v[20:23], v[196:199], v[188:191], v[20:23]
    s_waitcnt lgkmcnt(10)
    v_mfma_f32_16x16x32_bf16 v[24:27], v[200:203], v[180:183], v[24:27]
    v_mfma_f32_16x16x32_bf16 v[28:31], v[200:203], v[184:187], v[28:31]
    v_mfma_f32_16x16x32_bf16 v[32:35], v[200:203], v[188:191], v[32:35]
    s_waitcnt lgkmcnt(8)
    v_mfma_f32_16x16x32_bf16 v[36:39], v[204:207], v[180:183], v[36:39]
    v_mfma_f32_16x16x32_bf16 v[40:43], v[204:207], v[184:187], v[40:43]
    v_mfma_f32_16x16x32_bf16 v[44:47], v[204:207], v[188:191], v[44:47]
    s_waitcnt lgkmcnt(6)
    v_mfma_f32_16x16x32_bf16 v[48:51], v[208:211], v[180:183], v[48:51]
    v_mfma_f32_16x16x32_bf16 v[52:55], v[208:211], v[184:187], v[52:55]
    v_mfma_f32_16x16x32_bf16 v[56:59], v[208:211], v[188:191], v[56:59]
    s_waitcnt lgkmcnt(4)
    v_mfma_f32_16x16x32_bf16 v[60:63], v[212:215], v[180:183], v[60:63]
    v_mfma_f32_16x16x32_bf16 v[64:67], v[212:215], v[184:187], v[64:67]
    v_mfma_f32_16x16x32_bf16 v[68:71], v[212:215], v[188:191], v[68:71]
    s_waitcnt lgkmcnt(2)
    v_mfma_f32_16x16x32_bf16 v[72:75], v[216:219], v[180:183], v[72:75]
    v_mfma_f32_16x16x32_bf16 v[76:79], v[216:219], v[184:187], v[76:79]
    v_mfma_f32_16x16x32_bf16 v[80:83], v[216:219], v[188:191], v[80:83]
    s_waitcnt lgkmcnt(0)
    v_mfma_f32_16x16x32_bf16 v[84:87], v[220:223], v[180:183], v[84:87]
    v_mfma_f32_16x16x32_bf16 v[88:91], v[220:223], v[184:187], v[88:91]
    v_mfma_f32_16x16x32_bf16 v[92:95], v[220:223], v[188:191], v[92:95]
    v_cvt_pk_bf16_f32 v96, v0, v1
    v_cvt_pk_bf16_f32 v97, v2, v3
    v_cvt_pk_bf16_f32 v98, v12, v13
    v_cvt_pk_bf16_f32 v99, v14, v15
    v_cvt_pk_bf16_f32 v100, v4, v5
    v_cvt_pk_bf16_f32 v101, v6, v7
    v_cvt_pk_bf16_f32 v102, v16, v17
    v_cvt_pk_bf16_f32 v103, v18, v19
    v_cvt_pk_bf16_f32 v104, v8, v9
    v_cvt_pk_bf16_f32 v105, v10, v11
    v_cvt_pk_bf16_f32 v106, v20, v21
    v_cvt_pk_bf16_f32 v107, v22, v23
    v_cvt_pk_bf16_f32 v108, v24, v25
    v_cvt_pk_bf16_f32 v109, v26, v27
    v_cvt_pk_bf16_f32 v110, v36, v37
    v_cvt_pk_bf16_f32 v111, v38, v39
    v_cvt_pk_bf16_f32 v112, v28, v29
    v_cvt_pk_bf16_f32 v113, v30, v31
    v_cvt_pk_bf16_f32 v114, v40, v41
    v_cvt_pk_bf16_f32 v115, v42, v43
    v_cvt_pk_bf16_f32 v116, v32, v33
    v_cvt_pk_bf16_f32 v117, v34, v35
    v_cvt_pk_bf16_f32 v118, v44, v45
    v_cvt_pk_bf16_f32 v119, v46, v47
    v_cvt_pk_bf16_f32 v120, v48, v49
    v_cvt_pk_bf16_f32 v121, v50, v51
    v_cvt_pk_bf16_f32 v122, v60, v61
    v_cvt_pk_bf16_f32 v123, v62, v63
    v_cvt_pk_bf16_f32 v124, v52, v53
    v_cvt_pk_bf16_f32 v125, v54, v55
    v_cvt_pk_bf16_f32 v126, v64, v65
    v_cvt_pk_bf16_f32 v127, v66, v67
    v_cvt_pk_bf16_f32 v128, v56, v57
    v_cvt_pk_bf16_f32 v129, v58, v59
    v_cvt_pk_bf16_f32 v130, v68, v69
    v_cvt_pk_bf16_f32 v131, v70, v71
    v_cvt_pk_bf16_f32 v132, v72, v73
    v_cvt_pk_bf16_f32 v133, v74, v75
    v_cvt_pk_bf16_f32 v134, v84, v85
    v_cvt_pk_bf16_f32 v135, v86, v87
    v_cvt_pk_bf16_f32 v136, v76, v77
    v_cvt_pk_bf16_f32 v137, v78, v79
    v_cvt_pk_bf16_f32 v138, v88, v89
    v_cvt_pk_bf16_f32 v139, v90, v91
    v_cvt_pk_bf16_f32 v140, v80, v81
    v_cvt_pk_bf16_f32 v141, v82, v83
    v_cvt_pk_bf16_f32 v142, v92, v93
    v_cvt_pk_bf16_f32 v143, v94, v95
    v_permlane32_swap_b32 v96, v98
    v_permlane32_swap_b32 v97, v99
    v_permlane32_swap_b32 v100, v102
    v_permlane32_swap_b32 v101, v103
    v_permlane32_swap_b32 v104, v106
    v_permlane32_swap_b32 v105, v107
    v_permlane32_swap_b32 v108, v110
    v_permlane32_swap_b32 v109, v111
    v_permlane32_swap_b32 v112, v114
    v_permlane32_swap_b32 v113, v115
    v_permlane32_swap_b32 v116, v118
    v_permlane32_swap_b32 v117, v119
    v_permlane32_swap_b32 v120, v122
    v_permlane32_swap_b32 v121, v123
    v_permlane32_swap_b32 v124, v126
    v_permlane32_swap_b32 v125, v127
    v_permlane32_swap_b32 v128, v130
    v_permlane32_swap_b32 v129, v131
    v_permlane32_swap_b32 v132, v134
    v_permlane32_swap_b32 v133, v135
    v_permlane32_swap_b32 v136, v138
    v_permlane32_swap_b32 v137, v139
    v_permlane32_swap_b32 v140, v142
    v_permlane32_swap_b32 v141, v143
    v_permlane16_swap_b32 v96, v98
    v_permlane16_swap_b32 v97, v99
    v_permlane16_swap_b32 v100, v102
    v_permlane16_swap_b32 v101, v103
    v_permlane16_swap_b32 v104, v106
    v_permlane16_swap_b32 v105, v107
    v_permlane16_swap_b32 v108, v110
    v_permlane16_swap_b32 v109, v111
    v_permlane16_swap_b32 v112, v114
    v_permlane16_swap_b32 v113, v115
    v_permlane16_swap_b32 v116, v118
    v_permlane16_swap_b32 v117, v119
    v_permlane16_swap_b32 v120, v122
    v_permlane16_swap_b32 v121, v123
    v_permlane16_swap_b32 v124, v126
    v_permlane16_swap_b32 v125, v127
    v_permlane16_swap_b32 v128, v130
    v_permlane16_swap_b32 v129, v131
    v_permlane16_swap_b32 v132, v134
    v_permlane16_swap_b32 v133, v135
    v_permlane16_swap_b32 v136, v138
    v_permlane16_swap_b32 v137, v139
    v_permlane16_swap_b32 v140, v142
    v_permlane16_swap_b32 v141, v143
    v_mov_b32 v0, 0
    v_mov_b32 v1, 0
    v_mov_b32 v2, 0
    v_mov_b32 v3, 0
    v_mov_b32 v4, 0
    v_mov_b32 v5, 0
    v_mov_b32 v6, 0
    v_mov_b32 v7, 0
    v_mov_b32 v8, 0
    v_mov_b32 v9, 0
    v_mov_b32 v10, 0
    v_mov_b32 v11, 0
    v_mov_b32 v12, 0
    v_mov_b32 v13, 0
    v_mov_b32 v14, 0
    v_mov_b32 v15, 0
    v_mov_b32 v16, 0
    v_mov_b32 v17, 0
    v_mov_b32 v18, 0
    v_mov_b32 v19, 0
    v_mov_b32 v20, 0
    v_mov_b32 v21, 0
    v_mov_b32 v22, 0
    v_mov_b32 v23, 0
    v_mov_b32 v24, 0
    v_mov_b32 v25, 0
    v_mov_b32 v26, 0
    v_mov_b32 v27, 0
    v_mov_b32 v28, 0
    v_mov_b32 v29, 0
    v_mov_b32 v30, 0
    v_mov_b32 v31, 0
    v_mov_b32 v32, 0
    v_mov_b32 v33, 0
    v_mov_b32 v34, 0
    v_mov_b32 v35, 0
    v_mov_b32 v36, 0
    v_mov_b32 v37, 0
    v_mov_b32 v38, 0
    v_mov_b32 v39, 0
    v_mov_b32 v40, 0
    v_mov_b32 v41, 0
    v_mov_b32 v42, 0
    v_mov_b32 v43, 0
    v_mov_b32 v44, 0
    v_mov_b32 v45, 0
    v_mov_b32 v46, 0
    v_mov_b32 v47, 0
    v_mov_b32 v48, 0
    v_mov_b32 v49, 0
    v_mov_b32 v50, 0
    v_mov_b32 v51, 0
    v_mov_b32 v52, 0
    v_mov_b32 v53, 0
    v_mov_b32 v54, 0
    v_mov_b32 v55, 0
    v_mov_b32 v56, 0
    v_mov_b32 v57, 0
    v_mov_b32 v58, 0
    v_mov_b32 v59, 0
    v_mov_b32 v60, 0
    v_mov_b32 v61, 0
    v_mov_b32 v62, 0
    v_mov_b32 v63, 0
    v_mov_b32 v64, 0
    v_mov_b32 v65, 0
    v_mov_b32 v66, 0
    v_mov_b32 v67, 0
    v_mov_b32 v68, 0
    v_mov_b32 v69, 0
    v_mov_b32 v70, 0
    v_mov_b32 v71, 0
    v_mov_b32 v72, 0
    v_mov_b32 v73, 0
    v_mov_b32 v74, 0
    v_mov_b32 v75, 0
    v_mov_b32 v76, 0
    v_mov_b32 v77, 0
    v_mov_b32 v78, 0
    v_mov_b32 v79, 0
    v_mov_b32 v80, 0
    v_mov_b32 v81, 0
    v_mov_b32 v82, 0
    v_mov_b32 v83, 0
    v_mov_b32 v84, 0
    v_mov_b32 v85, 0
    v_mov_b32 v86, 0
    v_mov_b32 v87, 0
    v_mov_b32 v88, 0
    v_mov_b32 v89, 0
    v_mov_b32 v90, 0
    v_mov_b32 v91, 0
    v_mov_b32 v92, 0
    v_mov_b32 v93, 0
    v_mov_b32 v94, 0
    v_mov_b32 v95, 0
    v_mov_b32 v238, 0xf149f2ca
    v_mov_b32 v241, 0
    v_mov_b32 v239, 0xf149f2ca
    v_mov_b32 v242, 0
    v_mov_b32 v240, 0xf149f2ca
    v_mov_b32 v243, 0
    s_mov_b32 s53, 2
    s_mov_b32 s54, 1
    s_mov_b32 s34, 8
    s_nop 7
L_attn_loop:
    s_waitcnt vmcnt(8)
    s_barrier
    s_add_u32 m0, s29, 49152
    s_add_u32 s32, s35, s54
    s_and_b32 s32, s32, 15
    s_lshl_b32 s32, s32, 14
    s_cmp_ge_u32 s54, 16
    s_cselect_b32 s32, 0x40000000, s32
    s_add_u32 s54, s54, 1
    buffer_load_dwordx4 v236, s[12:15], s32 offen offset:0 nt lds
    buffer_load_dwordx4 v237, s[12:15], s32 offen offset:1024 nt lds
    buffer_load_dwordx4 v236, s[12:15], s32 offen offset:2048 nt lds
    buffer_load_dwordx4 v237, s[12:15], s32 offen offset:3072 nt lds
    ds_read_b128 v[192:195], v224 offset:0
    ds_read_b128 v[196:199], v225 offset:0
    ds_read_b128 v[200:203], v226 offset:0
    ds_read_b128 v[204:207], v227 offset:0
    ds_read_b128 v[208:211], v224 offset:4096
    ds_read_b128 v[212:215], v225 offset:4096
    ds_read_b128 v[216:219], v226 offset:4096
    ds_read_b128 v[220:223], v227 offset:4096
    s_waitcnt lgkmcnt(7)
    v_mfma_f32_16x16x32_bf16 v[144:147], v[192:195], v[96:99], 0
    v_mfma_f32_16x16x32_bf16 v[148:151], v[192:195], v[100:103], 0
    v_mfma_f32_16x16x32_bf16 v[152:155], v[192:195], v[104:107], 0
    ds_read_b128 v[192:195], v224 offset:8192
    s_waitcnt lgkmcnt(7)
    v_mfma_f32_16x16x32_bf16 v[144:147], v[196:199], v[108:111], v[144:147]
    v_mfma_f32_16x16x32_bf16 v[148:151], v[196:199], v[112:115], v[148:151]
    v_mfma_f32_16x16x32_bf16 v[152:155], v[196:199], v[116:119], v[152:155]
    ds_read_b128 v[196:199], v225 offset:8192
    s_waitcnt lgkmcnt(7)
    v_mfma_f32_16x16x32_bf16 v[144:147], v[200:203], v[120:123], v[144:147]
    v_mfma_f32_16x16x32_bf16 v[148:151], v[200:203], v[124:127], v[148:151]
    v_mfma_f32_16x16x32_bf16 v[152:155], v[200:203], v[128:131], v[152:155]
    ds_read_b128 v[200:203], v226 offset:8192
    s_waitcnt lgkmcnt(7)
    v_mfma_f32_16x16x32_bf16 v[144:147], v[204:207], v[132:135], v[144:147]
    v_mfma_f32_16x16x32_bf16 v[148:151], v[204:207], v[136:139], v[148:151]
    v_mfma_f32_16x16x32_bf16 v[152:155], v[204:207], v[140:143], v[152:155]
    ds_read_b128 v[204:207], v227 offset:8192
    s_waitcnt lgkmcnt(7)
    v_mfma_f32_16x16x32_bf16 v[156:159], v[208:211], v[96:99], 0
    v_mfma_f32_16x16x32_bf16 v[160:163], v[208:211], v[100:103], 0
    v_mfma_f32_16x16x32_bf16 v[164:167], v[208:211], v[104:107], 0
    ds_read_b128 v[208:211], v224 offset:12288
    s_waitcnt lgkmcnt(7)
    v_mfma_f32_16x16x32_bf16 v[156:159], v[212:215], v[108:111], v[156:159]
    v_mfma_f32_16x16x32_bf16 v[160:163], v[212:215], v[112:115], v[160:163]
    v_mfma_f32_16x16x32_bf16 v[164:167], v[212:215], v[116:119], v[164:167]
    ds_read_b128 v[212:215], v225 offset:12288
    s_waitcnt lgkmcnt(7)
    v_mfma_f32_16x16x32_bf16 v[156:159], v[216:219], v[120:123], v[156:159]
    v_mfma_f32_16x16x32_bf16 v[160:163], v[216:219], v[124:127], v[160:163]
    v_mfma_f32_16x16x32_bf16 v[164:167], v[216:219], v[128:131], v[164:167]
    ds_read_b128 v[216:219], v226 offset:12288
    s_waitcnt lgkmcnt(7)
    v_mfma_f32_16x16x32_bf16 v[156:159], v[220:223], v[132:135], v[156:159]
    v_mfma_f32_16x16x32_bf16 v[160:163], v[220:223], v[136:139], v[160:163]
    v_mfma_f32_16x16x32_bf16 v[164:167], v[220:223], v[140:143], v[164:167]
    ds_read_b128 v[220:223], v227 offset:12288
    s_waitcnt lgkmcnt(7)
    v_mfma_f32_16x16x32_bf16 v[168:171], v[192:195], v[96:99], 0
    v_mfma_f32_16x16x32_bf16 v[172:175], v[192:195], v[100:103], 0
    v_mfma_f32_16x16x32_bf16 v[176:179], v[192:195], v[104:107], 0
    s_waitcnt lgkmcnt(6)
    v_mfma_f32_16x16x32_bf16 v[168:171], v[196:199], v[108:111], v[168:171]
    v_mfma_f32_16x16x32_bf16 v[172:175], v[196:199], v[112:115], v[172:175]
    v_mfma_f32_16x16x32_bf16 v[176:179], v[196:199], v[116:119], v[176:179]
    s_waitcnt lgkmcnt(5)
    v_mfma_f32_16x16x32_bf16 v[168:171], v[200:203], v[120:123], v[168:171]
    v_mfma_f32_16x16x32_bf16 v[172:175], v[200:203], v[124:127], v[172:175]
    v_mfma_f32_16x16x32_bf16 v[176:179], v[200:203], v[128:131], v[176:179]
    s_waitcnt lgkmcnt(4)
    v_mfma_f32_16x16x32_bf16 v[168:171], v[204:207], v[132:135], v[168:171]
    v_mfma_f32_16x16x32_bf16 v[172:175], v[204:207], v[136:139], v[172:175]
    v_mfma_f32_16x16x32_bf16 v[176:179], v[204:207], v[140:143], v[176:179]
    s_waitcnt lgkmcnt(3)
    v_mfma_f32_16x16x32_bf16 v[180:183], v[208:211], v[96:99], 0
    v_mfma_f32_16x16x32_bf16 v[184:187], v[208:211], v[100:103], 0
    v_mfma_f32_16x16x32_bf16 v[188:191], v[208:211], v[104:107], 0
    s_waitcnt lgkmcnt(2)
    v_mfma_f32_16x16x32_bf16 v[180:183], v[212:215], v[108:111], v[180:183]
    v_mfma_f32_16x16x32_bf16 v[184:187], v[212:215], v[112:115], v[184:187]
    v_mfma_f32_16x16x32_bf16 v[188:191], v[212:215], v[116:119], v[188:191]
    s_waitcnt lgkmcnt(1)
    v_mfma_f32_16x16x32_bf16 v[180:183], v[216:219], v[120:123], v[180:183]
    v_mfma_f32_16x16x32_bf16 v[184:187], v[216:219], v[124:127], v[184:187]
    v_mfma_f32_16x16x32_bf16 v[188:191], v[216:219], v[128:131], v[188:191]
    s_waitcnt lgkmcnt(0)
    v_mfma_f32_16x16x32_bf16 v[180:183], v[220:223], v[132:135], v[180:183]
    v_mfma_f32_16x16x32_bf16 v[184:187], v[220:223], v[136:139], v[184:187]
    v_mfma_f32_16x16x32_bf16 v[188:191], v[220:223], v[140:143], v[188:191]
    v_max3_f32 v244, v144, v145, v146
    v_max3_f32 v244, v244, v147, v156
    v_max3_f32 v244, v244, v157, v158
    v_max3_f32 v244, v244, v159, v168
    v_max3_f32 v244, v244, v169, v170
    s_nop 0
    v_max3_f32 v244, v244, v171, v180
    v_max3_f32 v244, v244, v181, v182
    v_max3_f32 v244, v244, v183, v183
    v_max3_f32 v245, v148, v149, v150
    v_max3_f32 v245, v245, v151, v160
    v_max3_f32 v245, v245, v161, v162
    v_max3_f32 v245, v245, v163, v172
    v_max3_f32 v245, v245, v173, v174
    v_max3_f32 v245, v245, v175, v184
    v_max3_f32 v245, v245, v185, v186
    v_max3_f32 v245, v245, v187, v187
    v_max3_f32 v246, v152, v153, v154
    v_max3_f32 v246, v246, v155, v164
    v_max3_f32 v246, v246, v165, v166
    v_max3_f32 v246, v246, v167, v176
    v_max3_f32 v246, v246, v177, v178
    v_max3_f32 v246, v246, v179, v188
    v_max3_f32 v246, v246, v189, v190
    v_max3_f32 v246, v246, v191, v191
    v_mov_b32 v247, v244
    v_mov_b32 v248, v245
    v_mov_b32 v249, v246
    v_permlane32_swap_b32 v244, v247
    v_permlane32_swap_b32 v245, v248
    v_permlane32_swap_b32 v246, v249
    v_max_f32 v244, v244, v247
    v_max_f32 v245, v245, v248
    v_max_f32 v246, v246, v249
    v_mov_b32 v247, v244
    v_mov_b32 v248, v245
    v_mov_b32 v249, v246
    v_permlane16_swap_b32 v244, v247
    v_permlane16_swap_b32 v245, v248
    v_permlane16_swap_b32 v246, v249
    v_max_f32 v244, v244, v247
    v_max_f32 v245, v245, v248
    v_max_f32 v246, v246, v249
    v_mul_f32 v244, s33, v244
    v_mul_f32 v245, s33, v245
    v_mul_f32 v246, s33, v246
    v_sub_f32 v247, v244, v238
    v_sub_f32 v248, v245, v239
    v_sub_f32 v249, v246, v240
    v_max3_f32 v247, v247, v248, v249
    v_cmp_lt_f32 vcc, 0x41000000, v247
    s_nop 4
    s_cbranch_vccz L_attn_nors0
    v_max_f32 v244, v244, v238
    v_max_f32 v245, v245, v239
    v_max_f32 v246, v246, v240
    v_sub_f32 v247, v238, v244
    v_sub_f32 v248, v239, v245
    v_sub_f32 v249, v240, v246
    v_exp_f32 v247, v247
    v_exp_f32 v248, v248
    v_exp_f32 v249, v249
    v_mov_b32 v238, v244
    v_mov_b32 v239, v245
    v_mov_b32 v240, v246
    v_mul_f32 v241, v241, v247
    v_mul_f32 v242, v242, v248
    v_mul_f32 v243, v243, v249
    v_mul_f32 v0, v0, v247
    v_mul_f32 v1, v1, v247
    v_mul_f32 v2, v2, v247
    v_mul_f32 v3, v3, v247
    v_mul_f32 v4, v4, v248
    v_mul_f32 v5, v5, v248
    v_mul_f32 v6, v6, v248
    v_mul_f32 v7, v7, v248
    v_mul_f32 v8, v8, v249
    v_mul_f32 v9, v9, v249
    v_mul_f32 v10, v10, v249
    v_mul_f32 v11, v11, v249
    v_mul_f32 v12, v12, v247
    v_mul_f32 v13, v13, v247
    v_mul_f32 v14, v14, v247
    v_mul_f32 v15, v15, v247
    v_mul_f32 v16, v16, v248
    v_mul_f32 v17, v17, v248
    v_mul_f32 v18, v18, v248
    v_mul_f32 v19, v19, v248
    v_mul_f32 v20, v20, v249
    v_mul_f32 v21, v21, v249
    v_mul_f32 v22, v22, v249
    v_mul_f32 v23, v23, v249
    v_mul_f32 v24, v24, v247
    v_mul_f32 v25, v25, v247
    v_mul_f32 v26, v26, v247
    v_mul_f32 v27, v27, v247
    v_mul_f32 v28, v28, v248
    v_mul_f32 v29, v29, v248
    v_mul_f32 v30, v30, v248
    v_mul_f32 v31, v31, v248
    v_mul_f32 v32, v32, v249
    v_mul_f32 v33, v33, v249
    v_mul_f32 v34, v34, v249
    v_mul_f32 v35, v35, v249
    v_mul_f32 v36, v36, v247
    v_mul_f32 v37, v37, v247
    v_mul_f32 v38, v38, v247
    v_mul_f32 v39, v39, v247
    v_mul_f32 v40, v40, v248
    v_mul_f32 v41, v41, v248
    v_mul_f32 v42, v42, v248
    v_mul_f32 v43, v43, v248
    v_mul_f32 v44, v44, v249
    v_mul_f32 v45, v45, v249
    v_mul_f32 v46, v46, v249
    v_mul_f32 v47, v47, v249
    v_mul_f32 v48, v48, v247
    v_mul_f32 v49, v49, v247
    v_mul_f32 v50, v50, v247
    v_mul_f32 v51, v51, v247
    v_mul_f32 v52, v52, v248
    v_mul_f32 v53, v53, v248
    v_mul_f32 v54, v54, v248
    v_mul_f32 v55, v55, v248
    v_mul_f32 v56, v56, v249
    v_mul_f32 v57, v57, v249
    v_mul_f32 v58, v58, v249
    v_mul_f32 v59, v59, v249
    v_mul_f32 v60, v60, v247
    v_mul_f32 v61, v61, v247
    v_mul_f32 v62, v62, v247
    v_mul_f32 v63, v63, v247
    v_mul_f32 v64, v64, v248
    v_mul_f32 v65, v65, v248
    v_mul_f32 v66, v66, v248
    v_mul_f32 v67, v67, v248
    v_mul_f32 v68, v68, v249
    v_mul_f32 v69, v69, v249
    v_mul_f32 v70, v70, v249
    v_mul_f32 v71, v71, v249
    v_mul_f32 v72, v72, v247
    v_mul_f32 v73, v73, v247
    v_mul_f32 v74, v74, v247
    v_mul_f32 v75, v75, v247
    v_mul_f32 v76, v76, v248
    v_mul_f32 v77, v77, v248
    v_mul_f32 v78, v78, v248
    v_mul_f32 v79, v79, v248
    v_mul_f32 v80, v80, v249
    v_mul_f32 v81, v81, v249
    v_mul_f32 v82, v82, v249
    v_mul_f32 v83, v83, v249
    v_mul_f32 v84, v84, v247
    v_mul_f32 v85, v85, v247
    v_mul_f32 v86, v86, v247
    v_mul_f32 v87, v87, v247
    v_mul_f32 v88, v88, v248
    v_mul_f32 v89, v89, v248
    v_mul_f32 v90, v90, v248
    v_mul_f32 v91, v91, v248
    v_mul_f32 v92, v92, v249
    v_mul_f32 v93, v93, v249
    v_mul_f32 v94, v94, v249
    v_mul_f32 v95, v95, v249
L_attn_nors0:
    s_nop 7
    v_fma_f32 v144, v144, s33, -v238
    v_fma_f32 v145, v145, s33, -v238
    v_fma_f32 v146, v146, s33, -v238
    v_fma_f32 v147, v147, s33, -v238
    v_fma_f32 v156, v156, s33, -v238
    v_fma_f32 v157, v157, s33, -v238
    v_fma_f32 v158, v158, s33, -v238
    v_fma_f32 v159, v159, s33, -v238
    v_fma_f32 v168, v168, s33, -v238
    v_fma_f32 v169, v169, s33, -v238
    v_fma_f32 v170, v170, s33, -v238
    v_fma_f32 v171, v171, s33, -v238
    v_fma_f32 v180, v180, s33, -v238
    v_fma_f32 v181, v181, s33, -v238
    v_fma_f32 v182, v182, s33, -v238
    v_fma_f32 v183, v183, s33, -v238
    v_fma_f32 v148, v148, s33, -v239
    v_fma_f32 v149, v149, s33, -v239
    v_fma_f32 v150, v150, s33, -v239
    v_fma_f32 v151, v151, s33, -v239
    v_fma_f32 v160, v160, s33, -v239
    v_fma_f32 v161, v161, s33, -v239
    v_fma_f32 v162, v162, s33, -v239
    v_fma_f32 v163, v163, s33, -v239
    v_fma_f32 v172, v172, s33, -v239
    v_fma_f32 v173, v173, s33, -v239
    v_fma_f32 v174, v174, s33, -v239
    v_fma_f32 v175, v175, s33, -v239
    v_fma_f32 v184, v184, s33, -v239
    v_fma_f32 v185, v185, s33, -v239
    v_fma_f32 v186, v186, s33, -v239
    v_fma_f32 v187, v187, s33, -v239
    v_fma_f32 v152, v152, s33, -v240
    v_fma_f32 v153, v153, s33, -v240
    v_fma_f32 v154, v154, s33, -v240
    v_fma_f32 v155, v155, s33, -v240
    v_fma_f32 v164, v164, s33, -v240
    v_fma_f32 v165, v165, s33, -v240
    v_fma_f32 v166, v166, s33, -v240
    v_fma_f32 v167, v167, s33, -v240
    v_fma_f32 v176, v176, s33, -v240
    v_fma_f32 v177, v177, s33, -v240
    v_fma_f32 v178, v178, s33, -v240
    v_fma_f32 v179, v179, s33, -v240
    v_fma_f32 v188, v188, s33, -v240
    v_fma_f32 v189, v189, s33, -v240
    v_fma_f32 v190, v190, s33, -v240
    v_fma_f32 v191, v191, s33, -v240
    v_exp_f32 v144, v144
    v_exp_f32 v148, v148
    v_exp_f32 v152, v152
    v_exp_f32 v145, v145
    v_exp_f32 v149, v149
    v_exp_f32 v153, v153
    v_exp_f32 v146, v146
    v_exp_f32 v150, v150
    v_exp_f32 v154, v154
    v_exp_f32 v147, v147
    v_exp_f32 v151, v151
    v_exp_f32 v155, v155
    v_exp_f32 v156, v156
    v_exp_f32 v160, v160
    v_exp_f32 v164, v164
    v_exp_f32 v157, v157
    v_exp_f32 v161, v161
    v_exp_f32 v165, v165
    v_exp_f32 v158, v158
    v_exp_f32 v162, v162
    v_exp_f32 v166, v166
    v_exp_f32 v159, v159
    v_exp_f32 v163, v163
    v_exp_f32 v167, v167
    v_exp_f32 v168, v168
    v_exp_f32 v172, v172
    v_exp_f32 v176, v176
    v_exp_f32 v169, v169
    v_exp_f32 v173, v173
    v_exp_f32 v177, v177
    v_exp_f32 v170, v170
    v_exp_f32 v174, v174
    v_exp_f32 v178, v178
    v_exp_f32 v171, v171
    v_exp_f32 v175, v175
    v_exp_f32 v179, v179
    v_exp_f32 v180, v180
    v_exp_f32 v184, v184
    v_exp_f32 v188, v188
    v_exp_f32 v181, v181
    v_exp_f32 v185, v185
    v_exp_f32 v189, v189
    v_exp_f32 v182, v182
    v_exp_f32 v186, v186
    v_exp_f32 v190, v190
    v_exp_f32 v183, v183
    v_exp_f32 v187, v187
    v_exp_f32 v191, v191
    v_add_f32 v241, v241, v144
    v_add_f32 v242, v242, v148
    v_add_f32 v243, v243, v152
    v_add_f32 v241, v241, v145
    v_add_f32 v242, v242, v149
    v_add_f32 v243, v243, v153
    v_add_f32 v241, v241, v146
    v_add_f32 v242, v242, v150
    v_add_f32 v243, v243, v154
    v_add_f32 v241, v241, v147
    v_add_f32 v242, v242, v151
    v_add_f32 v243, v243, v155
    v_add_f32 v241, v241, v156
    v_add_f32 v242, v242, v160
    v_add_f32 v243, v243, v164
    v_add_f32 v241, v241, v157
    v_add_f32 v242, v242, v161
    v_add_f32 v243, v243, v165
    v_add_f32 v241, v241, v158
    v_add_f32 v242, v242, v162
    v_add_f32 v243, v243, v166
    v_add_f32 v241, v241, v159
    v_add_f32 v242, v242, v163
    v_add_f32 v243, v243, v167
    v_add_f32 v241, v241, v168
    v_add_f32 v242, v242, v172
    v_add_f32 v243, v243, v176
    v_add_f32 v241, v241, v169
    v_add_f32 v242, v242, v173
    v_add_f32 v243, v243, v177
    v_add_f32 v241, v241, v170
    v_add_f32 v242, v242, v174
    v_add_f32 v243, v243, v178
    v_add_f32 v241, v241, v171
    v_add_f32 v242, v242, v175
    v_add_f32 v243, v243, v179
    v_add_f32 v241, v241, v180
    v_add_f32 v242, v242, v184
    v_add_f32 v243, v243, v188
    v_add_f32 v241, v241, v181
    v_add_f32 v242, v242, v185
    v_add_f32 v243, v243, v189
    v_add_f32 v241, v241, v182
    v_add_f32 v242, v242, v186
    v_add_f32 v243, v243, v190
    v_add_f32 v241, v241, v183
    v_add_f32 v242, v242, v187
    v_add_f32 v243, v243, v191
    v_cvt_pk_bf16_f32 v144, v144, v145
    v_cvt_pk_bf16_f32 v145, v146, v147
    v_cvt_pk_bf16_f32 v146, v156, v157
    v_cvt_pk_bf16_f32 v147, v158, v159
    v_cvt_pk_bf16_f32 v148, v148, v149
    v_cvt_pk_bf16_f32 v149, v150, v151
    v_cvt_pk_bf16_f32 v150, v160, v161
    v_cvt_pk_bf16_f32 v151, v162, v163
    v_cvt_pk_bf16_f32 v152, v152, v153
    v_cvt_pk_bf16_f32 v153, v154, v155
    v_cvt_pk_bf16_f32 v154, v164, v165
    v_cvt_pk_bf16_f32 v155, v166, v167
    v_cvt_pk_bf16_f32 v168, v168, v169
    v_cvt_pk_bf16_f32 v169, v170, v171
    v_cvt_pk_bf16_f32 v170, v180, v181
    v_cvt_pk_bf16_f32 v171, v182, v183
    v_cvt_pk_bf16_f32 v172, v172, v173
    v_cvt_pk_bf16_f32 v173, v174, v175
    v_cvt_pk_bf16_f32 v174, v184, v185
    v_cvt_pk_bf16_f32 v175, v186, v187
    v_cvt_pk_bf16_f32 v176, v176, v177
    v_cvt_pk_bf16_f32 v177, v178, v179
    v_cvt_pk_bf16_f32 v178, v188, v189
    v_cvt_pk_bf16_f32 v179, v190, v191
    s_waitcnt vmcnt(8)
    s_barrier
    s_add_u32 m0, s29, 0
    s_add_u32 s32, s35, s53
    s_and_b32 s32, s32, 15
    s_lshl_b32 s32, s32, 14
    s_cmp_ge_u32 s53, 16
    s_cselect_b32 s32, 0x40000000, s32
    s_add_u32 s53, s53, 1
    buffer_load_dwordx4 v236, s[8:11], s32 offen offset:0 nt lds
    buffer_load_dwordx4 v237, s[8:11], s32 offen offset:1024 nt lds
    buffer_load_dwordx4 v236, s[8:11], s32 offen offset:2048 nt lds
    buffer_load_dwordx4 v237, s[8:11], s32 offen offset:3072 nt lds
    ds_read_b64_tr_b16 v[192:193], v228 offset:16384
    ds_read_b64_tr_b16 v[194:195], v228 offset:20480
    ds_read_b64_tr_b16 v[196:197], v229 offset:16384
    ds_read_b64_tr_b16 v[198:199], v229 offset:20480
    ds_read_b64_tr_b16 v[200:201], v230 offset:16384
    ds_read_b64_tr_b16 v[202:203], v230 offset:20480
    ds_read_b64_tr_b16 v[204:205], v231 offset:16384
    ds_read_b64_tr_b16 v[206:207], v231 offset:20480
    ds_read_b64_tr_b16 v[208:209], v232 offset:16384
    ds_read_b64_tr_b16 v[210:211], v232 offset:20480
    ds_read_b64_tr_b16 v[212:213], v233 offset:16384
    ds_read_b64_tr_b16 v[214:215], v233 offset:20480
    ds_read_b64_tr_b16 v[216:217], v234 offset:16384
    ds_read_b64_tr_b16 v[218:219], v234 offset:20480
    s_waitcnt lgkmcnt(12)
    v_mfma_f32_16x16x32_bf16 v[0:3], v[192:195], v[144:147], v[0:3]
    v_mfma_f32_16x16x32_bf16 v[4:7], v[192:195], v[148:151], v[4:7]
    v_mfma_f32_16x16x32_bf16 v[8:11], v[192:195], v[152:155], v[8:11]
    ds_read_b64_tr_b16 v[220:221], v235 offset:16384
    ds_read_b64_tr_b16 v[222:223], v235 offset:20480
    s_waitcnt lgkmcnt(12)
    v_mfma_f32_16x16x32_bf16 v[12:15], v[196:199], v[144:147], v[12:15]
    v_mfma_f32_16x16x32_bf16 v[16:19], v[196:199], v[148:151], v[16:19]
    v_mfma_f32_16x16x32_bf16 v[20:23], v[196:199], v[152:155], v[20:23]
    ds_read_b64_tr_b16 v[192:193], v228 offset:24576
    ds_read_b64_tr_b16 v[194:195], v228 offset:28672
    s_waitcnt lgkmcnt(12)
    v_mfma_f32_16x16x32_bf16 v[24:27], v[200:203], v[144:147], v[24:27]
    v_mfma_f32_16x16x32_bf16 v[28:31], v[200:203], v[148:151], v[28:31]
    v_mfma_f32_16x16x32_bf16 v[32:35], v[200:203], v[152:155], v[32:35]
    ds_read_b64_tr_b16 v[196:197], v229 offset:24576
    ds_read_b64_tr_b16 v[198:199], v229 offset:28672
    s_waitcnt lgkmcnt(12)
    v_mfma_f32_16x16x32_bf16 v[36:39], v[204:207], v[144:147], v[36:39]
    v_mfma_f32_16x16x32_bf16 v[40:43], v[204:207], v[148:151], v[40:43]
    v_mfma_f32_16x16x32_bf16 v[44:47], v[204:207], v[152:155], v[44:47]
    ds_read_b64_tr_b16 v[200:201], v230 offset:24576
    ds_read_b64_tr_b16 v[202:203], v230 offset:28672
    s_waitcnt lgkmcnt(12)
    v_mfma_f32_16x16x32_bf16 v[48:51], v[208:211], v[144:147], v[48:51]
    v_mfma_f32_16x16x32_bf16 v[52:55], v[208:211], v[148:151], v[52:55]
    v_mfma_f32_16x16x32_bf16 v[56:59], v[208:211], v[152:155], v[56:59]
    ds_read_b64_tr_b16 v[204:205], v231 offset:24576
    ds_read_b64_tr_b16 v[206:207], v231 offset:28672
    s_waitcnt lgkmcnt(12)
    v_mfma_f32_16x16x32_bf16 v[60:63], v[212:215], v[144:147], v[60:63]
    v_mfma_f32_16x16x32_bf16 v[64:67], v[212:215], v[148:151], v[64:67]
    v_mfma_f32_16x16x32_bf16 v[68:71], v[212:215], v[152:155], v[68:71]
    ds_read_b64_tr_b16 v[208:209], v232 offset:24576
    ds_read_b64_tr_b16 v[210:211], v232 offset:28672
    s_waitcnt lgkmcnt(12)
    v_mfma_f32_16x16x32_bf16 v[72:75], v[216:219], v[144:147], v[72:75]
    v_mfma_f32_16x16x32_bf16 v[76:79], v[216:219], v[148:151], v[76:79]
    v_mfma_f32_16x16x32_bf16 v[80:83], v[216:219], v[152:155], v[80:83]
    ds_read_b64_tr_b16 v[212:213], v233 offset:24576
    ds_read_b64_tr_b16 v[214:215], v233 offset:28672
    s_waitcnt lgkmcnt(12)
    v_mfma_f32_16x16x32_bf16 v[84:87], v[220:223], v[144:147], v[84:87]
    v_mfma_f32_16x16x32_bf16 v[88:91], v[220:223], v[148:151], v[88:91]
    v_mfma_f32_16x16x32_bf16 v[92:95], v[220:223], v[152:155], v[92:95]
    ds_read_b64_tr_b16 v[216:217], v234 offset:24576
    ds_read_b64_tr_b16 v[218:219], v234 offset:28672
    s_waitcnt lgkmcnt(12)
    v_mfma_f32_16x16x32_bf16 v[0:3], v[192:195], v[168:171], v[0:3]
    v_mfma_f32_16x16x32_bf16 v[4:7], v[192:195], v[172:175], v[4:7]
    v_mfma_f32_16x16x32_bf16 v[8:11], v[192:195], v[176:179], v[8:11]
    ds_read_b64_tr_b16 v[220:221], v235 offset:24576
    ds_read_b64_tr_b16 v[222:223], v235 offset:28672
    s_waitcnt lgkmcnt(12)
    v_mfma_f32_16x16x32_bf16 v[12:15], v[196:199], v[168:171], v[12:15]
    v_mfma_f32_16x16x32_bf16 v[16:19], v[196:199], v[172:175], v[16:19]
    v_mfma_f32_16x16x32_bf16 v[20:23], v[196:199], v[176:179], v[20:23]
    s_waitcnt lgkmcnt(10)
    v_mfma_f32_16x16x32_bf16 v[24:27], v[200:203], v[168:171], v[24:27]
    v_mfma_f32_16x16x32_bf16 v[28:31], v[200:203], v[172:175], v[28:31]
    v_mfma_f32_16x16x32_bf16 v[32:35], v[200:203], v[176:179], v[32:35]
    s_waitcnt lgkmcnt(8)
    v_mfma_f32_16x16x32_bf16 v[36:39], v[204:207], v[168:171], v[36:39]
    v_mfma_f32_16x16x32_bf16 v[40:43], v[204:207], v[172:175], v[40:43]
    v_mfma_f32_16x16x32_bf16 v[44:47], v[204:207], v[176:179], v[44:47]
    s_waitcnt lgkmcnt(6)
    v_mfma_f32_16x16x32_bf16 v[48:51], v[208:211], v[168:171], v[48:51]
    v_mfma_f32_16x16x32_bf16 v[52:55], v[208:211], v[172:175], v[52:55]
    v_mfma_f32_16x16x32_bf16 v[56:59], v[208:211], v[176:179], v[56:59]
    s_waitcnt lgkmcnt(4)
    v_mfma_f32_16x16x32_bf16 v[60:63], v[212:215], v[168:171], v[60:63]
    v_mfma_f32_16x16x32_bf16 v[64:67], v[212:215], v[172:175], v[64:67]
    v_mfma_f32_16x16x32_bf16 v[68:71], v[212:215], v[176:179], v[68:71]
    s_waitcnt lgkmcnt(2)
    v_mfma_f32_16x16x32_bf16 v[72:75], v[216:219], v[168:171], v[72:75]
    v_mfma_f32_16x16x32_bf16 v[76:79], v[216:219], v[172:175], v[76:79]
    v_mfma_f32_16x16x32_bf16 v[80:83], v[216:219], v[176:179], v[80:83]
    s_waitcnt lgkmcnt(0)
    v_mfma_f32_16x16x32_bf16 v[84:87], v[220:223], v[168:171], v[84:87]
    v_mfma_f32_16x16x32_bf16 v[88:91], v[220:223], v[172:175], v[88:91]
    v_mfma_f32_16x16x32_bf16 v[92:95], v[220:223], v[176:179], v[92:95]
    s_waitcnt vmcnt(8)
    s_barrier
    s_add_u32 m0, s29, 16384
    s_add_u32 s32, s35, s54
    s_and_b32 s32, s32, 15
    s_lshl_b32 s32, s32, 14
    s_cmp_ge_u32 s54, 16
    s_cselect_b32 s32, 0x40000000, s32
    s_add_u32 s54, s54, 1
    buffer_load_dwordx4 v236, s[12:15], s32 offen offset:0 nt lds
    buffer_load_dwordx4 v237, s[12:15], s32 offen offset:1024 nt lds
    buffer_load_dwordx4 v236, s[12:15], s32 offen offset:2048 nt lds
    buffer_load_dwordx4 v237, s[12:15], s32 offen offset:3072 nt lds
    ds_read_b128 v[192:195], v224 offset:32768
    ds_read_b128 v[196:199], v225 offset:32768
    ds_read_b128 v[200:203], v226 offset:32768
    ds_read_b128 v[204:207], v227 offset:32768
    ds_read_b128 v[208:211], v224 offset:36864
    ds_read_b128 v[212:215], v225 offset:36864
    ds_read_b128 v[216:219], v226 offset:36864
    ds_read_b128 v[220:223], v227 offset:36864
    s_waitcnt lgkmcnt(7)
    v_mfma_f32_16x16x32_bf16 v[144:147], v[192:195], v[96:99], 0
    v_mfma_f32_16x16x32_bf16 v[148:151], v[192:195], v[100:103], 0
    v_mfma_f32_16x16x32_bf16 v[152:155], v[192:195], v[104:107], 0
    ds_read_b128 v[192:195], v224 offset:40960
    s_waitcnt lgkmcnt(7)
    v_mfma_f32_16x16x32_bf16 v[144:147], v[196:199], v[108:111], v[144:147]
    v_mfma_f32_16x16x32_bf16 v[148:151], v[196:199], v[112:115], v[148:151]
    v_mfma_f32_16x16x32_bf16 v[152:155], v[196:199], v[116:119], v[152:155]
    ds_read_b128 v[196:199], v225 offset:40960
    s_waitcnt lgkmcnt(7)
    v_mfma_f32_16x16x32_bf16 v[144:147], v[200:203], v[120:123], v[144:147]
    v_mfma_f32_16x16x32_bf16 v[148:151], v[200:203], v[124:127], v[148:151]
    v_mfma_f32_16x16x32_bf16 v[152:155], v[200:203], v[128:131], v[152:155]
    ds_read_b128 v[200:203], v226 offset:40960
    s_waitcnt lgkmcnt(7)
    v_mfma_f32_16x16x32_bf16 v[144:147], v[204:207], v[132:135], v[144:147]
    v_mfma_f32_16x16x32_bf16 v[148:151], v[204:207], v[136:139], v[148:151]
    v_mfma_f32_16x16x32_bf16 v[152:155], v[204:207], v[140:143], v[152:155]
    ds_read_b128 v[204:207], v227 offset:40960
    s_waitcnt lgkmcnt(7)
    v_mfma_f32_16x16x32_bf16 v[156:159], v[208:211], v[96:99], 0
    v_mfma_f32_16x16x32_bf16 v[160:163], v[208:211], v[100:103], 0
    v_mfma_f32_16x16x32_bf16 v[164:167], v[208:211], v[104:107], 0
    ds_read_b128 v[208:211], v224 offset:45056
    s_waitcnt lgkmcnt(7)
    v_mfma_f32_16x16x32_bf16 v[156:159], v[212:215], v[108:111], v[156:159]
    v_mfma_f32_16x16x32_bf16 v[160:163], v[212:215], v[112:115], v[160:163]
    v_mfma_f32_16x16x32_bf16 v[164:167], v[212:215], v[116:119], v[164:167]
    ds_read_b128 v[212:215], v225 offset:45056
    s_waitcnt lgkmcnt(7)
    v_mfma_f32_16x16x32_bf16 v[156:159], v[216:219], v[120:123], v[156:159]
    v_mfma_f32_16x16x32_bf16 v[160:163], v[216:219], v[124:127], v[160:163]
    v_mfma_f32_16x16x32_bf16 v[164:167], v[216:219], v[128:131], v[164:167]
    ds_read_b128 v[216:219], v226 offset:45056
    s_waitcnt lgkmcnt(7)
    v_mfma_f32_16x16x32_bf16 v[156:159], v[220:223], v[132:135], v[156:159]
    v_mfma_f32_16x16x32_bf16 v[160:163], v[220:223], v[136:139], v[160:163]
    v_mfma_f32_16x16x32_bf16 v[164:167], v[220:223], v[140:143], v[164:167]
    ds_read_b128 v[220:223], v227 offset:45056
    s_waitcnt lgkmcnt(7)
    v_mfma_f32_16x16x32_bf16 v[168:171], v[192:195], v[96:99], 0
    v_mfma_f32_16x16x32_bf16 v[172:175], v[192:195], v[100:103], 0
    v_mfma_f32_16x16x32_bf16 v[176:179], v[192:195], v[104:107], 0
    s_waitcnt lgkmcnt(6)
    v_mfma_f32_16x16x32_bf16 v[168:171], v[196:199], v[108:111], v[168:171]
    v_mfma_f32_16x16x32_bf16 v[172:175], v[196:199], v[112:115], v[172:175]
    v_mfma_f32_16x16x32_bf16 v[176:179], v[196:199], v[116:119], v[176:179]
    s_waitcnt lgkmcnt(5)
    v_mfma_f32_16x16x32_bf16 v[168:171], v[200:203], v[120:123], v[168:171]
    v_mfma_f32_16x16x32_bf16 v[172:175], v[200:203], v[124:127], v[172:175]
    v_mfma_f32_16x16x32_bf16 v[176:179], v[200:203], v[128:131], v[176:179]
    s_waitcnt lgkmcnt(4)
    v_mfma_f32_16x16x32_bf16 v[168:171], v[204:207], v[132:135], v[168:171]
    v_mfma_f32_16x16x32_bf16 v[172:175], v[204:207], v[136:139], v[172:175]
    v_mfma_f32_16x16x32_bf16 v[176:179], v[204:207], v[140:143], v[176:179]
    s_waitcnt lgkmcnt(3)
    v_mfma_f32_16x16x32_bf16 v[180:183], v[208:211], v[96:99], 0
    v_mfma_f32_16x16x32_bf16 v[184:187], v[208:211], v[100:103], 0
    v_mfma_f32_16x16x32_bf16 v[188:191], v[208:211], v[104:107], 0
    s_waitcnt lgkmcnt(2)
    v_mfma_f32_16x16x32_bf16 v[180:183], v[212:215], v[108:111], v[180:183]
    v_mfma_f32_16x16x32_bf16 v[184:187], v[212:215], v[112:115], v[184:187]
    v_mfma_f32_16x16x32_bf16 v[188:191], v[212:215], v[116:119], v[188:191]
    s_waitcnt lgkmcnt(1)
    v_mfma_f32_16x16x32_bf16 v[180:183], v[216:219], v[120:123], v[180:183]
    v_mfma_f32_16x16x32_bf16 v[184:187], v[216:219], v[124:127], v[184:187]
    v_mfma_f32_16x16x32_bf16 v[188:191], v[216:219], v[128:131], v[188:191]
    s_waitcnt lgkmcnt(0)
    v_mfma_f32_16x16x32_bf16 v[180:183], v[220:223], v[132:135], v[180:183]
    v_mfma_f32_16x16x32_bf16 v[184:187], v[220:223], v[136:139], v[184:187]
    v_mfma_f32_16x16x32_bf16 v[188:191], v[220:223], v[140:143], v[188:191]
    v_max3_f32 v244, v144, v145, v146
    v_max3_f32 v244, v244, v147, v156
    v_max3_f32 v244, v244, v157, v158
    v_max3_f32 v244, v244, v159, v168
    v_max3_f32 v244, v244, v169, v170
    s_nop 0
    v_max3_f32 v244, v244, v171, v180
    v_max3_f32 v244, v244, v181, v182
    v_max3_f32 v244, v244, v183, v183
    v_max3_f32 v245, v148, v149, v150
    v_max3_f32 v245, v245, v151, v160
    v_max3_f32 v245, v245, v161, v162
    v_max3_f32 v245, v245, v163, v172
    v_max3_f32 v245, v245, v173, v174
    v_max3_f32 v245, v245, v175, v184
    v_max3_f32 v245, v245, v185, v186
    v_max3_f32 v245, v245, v187, v187
    v_max3_f32 v246, v152, v153, v154
    v_max3_f32 v246, v246, v155, v164
    v_max3_f32 v246, v246, v165, v166
    v_max3_f32 v246, v246, v167, v176
    v_max3_f32 v246, v246, v177, v178
    v_max3_f32 v246, v246, v179, v188
    v_max3_f32 v246, v246, v189, v190
    v_max3_f32 v246, v246, v191, v191
    v_mov_b32 v247, v244
    v_mov_b32 v248, v245
    v_mov_b32 v249, v246
    v_permlane32_swap_b32 v244, v247
    v_permlane32_swap_b32 v245, v248
    v_permlane32_swap_b32 v246, v249
    v_max_f32 v244, v244, v247
    v_max_f32 v245, v245, v248
    v_max_f32 v246, v246, v249
    v_mov_b32 v247, v244
    v_mov_b32 v248, v245
    v_mov_b32 v249, v246
    v_permlane16_swap_b32 v244, v247
    v_permlane16_swap_b32 v245, v248
    v_permlane16_swap_b32 v246, v249
    v_max_f32 v244, v244, v247
    v_max_f32 v245, v245, v248
    v_max_f32 v246, v246, v249
    v_mul_f32 v244, s33, v244
    v_mul_f32 v245, s33, v245
    v_mul_f32 v246, s33, v246
    v_sub_f32 v247, v244, v238
    v_sub_f32 v248, v245, v239
    v_sub_f32 v249, v246, v240
    v_max3_f32 v247, v247, v248, v249
    v_cmp_lt_f32 vcc, 0x41000000, v247
    s_nop 4
    s_cbranch_vccz L_attn_nors1
    v_max_f32 v244, v244, v238
    v_max_f32 v245, v245, v239
    v_max_f32 v246, v246, v240
    v_sub_f32 v247, v238, v244
    v_sub_f32 v248, v239, v245
    v_sub_f32 v249, v240, v246
    v_exp_f32 v247, v247
    v_exp_f32 v248, v248
    v_exp_f32 v249, v249
    v_mov_b32 v238, v244
    v_mov_b32 v239, v245
    v_mov_b32 v240, v246
    v_mul_f32 v241, v241, v247
    v_mul_f32 v242, v242, v248
    v_mul_f32 v243, v243, v249
    v_mul_f32 v0, v0, v247
    v_mul_f32 v1, v1, v247
    v_mul_f32 v2, v2, v247
    v_mul_f32 v3, v3, v247
    v_mul_f32 v4, v4, v248
    v_mul_f32 v5, v5, v248
    v_mul_f32 v6, v6, v248
    v_mul_f32 v7, v7, v248
    v_mul_f32 v8, v8, v249
    v_mul_f32 v9, v9, v249
    v_mul_f32 v10, v10, v249
    v_mul_f32 v11, v11, v249
    v_mul_f32 v12, v12, v247
    v_mul_f32 v13, v13, v247
    v_mul_f32 v14, v14, v247
    v_mul_f32 v15, v15, v247
    v_mul_f32 v16, v16, v248
    v_mul_f32 v17, v17, v248
    v_mul_f32 v18, v18, v248
    v_mul_f32 v19, v19, v248
    v_mul_f32 v20, v20, v249
    v_mul_f32 v21, v21, v249
    v_mul_f32 v22, v22, v249
    v_mul_f32 v23, v23, v249
    v_mul_f32 v24, v24, v247
    v_mul_f32 v25, v25, v247
    v_mul_f32 v26, v26, v247
    v_mul_f32 v27, v27, v247
    v_mul_f32 v28, v28, v248
    v_mul_f32 v29, v29, v248
    v_mul_f32 v30, v30, v248
    v_mul_f32 v31, v31, v248
    v_mul_f32 v32, v32, v249
    v_mul_f32 v33, v33, v249
    v_mul_f32 v34, v34, v249
    v_mul_f32 v35, v35, v249
    v_mul_f32 v36, v36, v247
    v_mul_f32 v37, v37, v247
    v_mul_f32 v38, v38, v247
    v_mul_f32 v39, v39, v247
    v_mul_f32 v40, v40, v248
    v_mul_f32 v41, v41, v248
    v_mul_f32 v42, v42, v248
    v_mul_f32 v43, v43, v248
    v_mul_f32 v44, v44, v249
    v_mul_f32 v45, v45, v249
    v_mul_f32 v46, v46, v249
    v_mul_f32 v47, v47, v249
    v_mul_f32 v48, v48, v247
    v_mul_f32 v49, v49, v247
    v_mul_f32 v50, v50, v247
    v_mul_f32 v51, v51, v247
    v_mul_f32 v52, v52, v248
    v_mul_f32 v53, v53, v248
    v_mul_f32 v54, v54, v248
    v_mul_f32 v55, v55, v248
    v_mul_f32 v56, v56, v249
    v_mul_f32 v57, v57, v249
    v_mul_f32 v58, v58, v249
    v_mul_f32 v59, v59, v249
    v_mul_f32 v60, v60, v247
    v_mul_f32 v61, v61, v247
    v_mul_f32 v62, v62, v247
    v_mul_f32 v63, v63, v247
    v_mul_f32 v64, v64, v248
    v_mul_f32 v65, v65, v248
    v_mul_f32 v66, v66, v248
    v_mul_f32 v67, v67, v248
    v_mul_f32 v68, v68, v249
    v_mul_f32 v69, v69, v249
    v_mul_f32 v70, v70, v249
    v_mul_f32 v71, v71, v249
    v_mul_f32 v72, v72, v247
    v_mul_f32 v73, v73, v247
    v_mul_f32 v74, v74, v247
    v_mul_f32 v75, v75, v247
    v_mul_f32 v76, v76, v248
    v_mul_f32 v77, v77, v248
    v_mul_f32 v78, v78, v248
    v_mul_f32 v79, v79, v248
    v_mul_f32 v80, v80, v249
    v_mul_f32 v81, v81, v249
    v_mul_f32 v82, v82, v249
    v_mul_f32 v83, v83, v249
    v_mul_f32 v84, v84, v247
    v_mul_f32 v85, v85, v247
    v_mul_f32 v86, v86, v247
    v_mul_f32 v87, v87, v247
    v_mul_f32 v88, v88, v248
    v_mul_f32 v89, v89, v248
    v_mul_f32 v90, v90, v248
    v_mul_f32 v91, v91, v248
    v_mul_f32 v92, v92, v249
    v_mul_f32 v93, v93, v249
    v_mul_f32 v94, v94, v249
    v_mul_f32 v95, v95, v249
L_attn_nors1:
    s_nop 7
    v_fma_f32 v144, v144, s33, -v238
    v_fma_f32 v145, v145, s33, -v238
    v_fma_f32 v146, v146, s33, -v238
    v_fma_f32 v147, v147, s33, -v238
    v_fma_f32 v156, v156, s33, -v238
    v_fma_f32 v157, v157, s33, -v238
    v_fma_f32 v158, v158, s33, -v238
    v_fma_f32 v159, v159, s33, -v238
    v_fma_f32 v168, v168, s33, -v238
    v_fma_f32 v169, v169, s33, -v238
    v_fma_f32 v170, v170, s33, -v238
    v_fma_f32 v171, v171, s33, -v238
    v_fma_f32 v180, v180, s33, -v238
    v_fma_f32 v181, v181, s33, -v238
    v_fma_f32 v182, v182, s33, -v238
    v_fma_f32 v183, v183, s33, -v238
    v_fma_f32 v148, v148, s33, -v239
    v_fma_f32 v149, v149, s33, -v239
    v_fma_f32 v150, v150, s33, -v239
    v_fma_f32 v151, v151, s33, -v239
    v_fma_f32 v160, v160, s33, -v239
    v_fma_f32 v161, v161, s33, -v239
    v_fma_f32 v162, v162, s33, -v239
    v_fma_f32 v163, v163, s33, -v239
    v_fma_f32 v172, v172, s33, -v239
    v_fma_f32 v173, v173, s33, -v239
    v_fma_f32 v174, v174, s33, -v239
    v_fma_f32 v175, v175, s33, -v239
    v_fma_f32 v184, v184, s33, -v239
    v_fma_f32 v185, v185, s33, -v239
    v_fma_f32 v186, v186, s33, -v239
    v_fma_f32 v187, v187, s33, -v239
    v_fma_f32 v152, v152, s33, -v240
    v_fma_f32 v153, v153, s33, -v240
    v_fma_f32 v154, v154, s33, -v240
    v_fma_f32 v155, v155, s33, -v240
    v_fma_f32 v164, v164, s33, -v240
    v_fma_f32 v165, v165, s33, -v240
    v_fma_f32 v166, v166, s33, -v240
    v_fma_f32 v167, v167, s33, -v240
    v_fma_f32 v176, v176, s33, -v240
    v_fma_f32 v177, v177, s33, -v240
    v_fma_f32 v178, v178, s33, -v240
    v_fma_f32 v179, v179, s33, -v240
    v_fma_f32 v188, v188, s33, -v240
    v_fma_f32 v189, v189, s33, -v240
    v_fma_f32 v190, v190, s33, -v240
    v_fma_f32 v191, v191, s33, -v240
    v_exp_f32 v144, v144
    v_exp_f32 v148, v148
    v_exp_f32 v152, v152
    v_exp_f32 v145, v145
    v_exp_f32 v149, v149
    v_exp_f32 v153, v153
    v_exp_f32 v146, v146
    v_exp_f32 v150, v150
    v_exp_f32 v154, v154
    v_exp_f32 v147, v147
    v_exp_f32 v151, v151
    v_exp_f32 v155, v155
    v_exp_f32 v156, v156
    v_exp_f32 v160, v160
    v_exp_f32 v164, v164
    v_exp_f32 v157, v157
    v_exp_f32 v161, v161
    v_exp_f32 v165, v165
    v_exp_f32 v158, v158
    v_exp_f32 v162, v162
    v_exp_f32 v166, v166
    v_exp_f32 v159, v159
    v_exp_f32 v163, v163
    v_exp_f32 v167, v167
    v_exp_f32 v168, v168
    v_exp_f32 v172, v172
    v_exp_f32 v176, v176
    v_exp_f32 v169, v169
    v_exp_f32 v173, v173
    v_exp_f32 v177, v177
    v_exp_f32 v170, v170
    v_exp_f32 v174, v174
    v_exp_f32 v178, v178
    v_exp_f32 v171, v171
    v_exp_f32 v175, v175
    v_exp_f32 v179, v179
    v_exp_f32 v180, v180
    v_exp_f32 v184, v184
    v_exp_f32 v188, v188
    v_exp_f32 v181, v181
    v_exp_f32 v185, v185
    v_exp_f32 v189, v189
    v_exp_f32 v182, v182
    v_exp_f32 v186, v186
    v_exp_f32 v190, v190
    v_exp_f32 v183, v183
    v_exp_f32 v187, v187
    v_exp_f32 v191, v191
    v_add_f32 v241, v241, v144
    v_add_f32 v242, v242, v148
    v_add_f32 v243, v243, v152
    v_add_f32 v241, v241, v145
    v_add_f32 v242, v242, v149
    v_add_f32 v243, v243, v153
    v_add_f32 v241, v241, v146
    v_add_f32 v242, v242, v150
    v_add_f32 v243, v243, v154
    v_add_f32 v241, v241, v147
    v_add_f32 v242, v242, v151
    v_add_f32 v243, v243, v155
    v_add_f32 v241, v241, v156
    v_add_f32 v242, v242, v160
    v_add_f32 v243, v243, v164
    v_add_f32 v241, v241, v157
    v_add_f32 v242, v242, v161
    v_add_f32 v243, v243, v165
    v_add_f32 v241, v241, v158
    v_add_f32 v242, v242, v162
    v_add_f32 v243, v243, v166
    v_add_f32 v241, v241, v159
    v_add_f32 v242, v242, v163
    v_add_f32 v243, v243, v167
    v_add_f32 v241, v241, v168
    v_add_f32 v242, v242, v172
    v_add_f32 v243, v243, v176
    v_add_f32 v241, v241, v169
    v_add_f32 v242, v242, v173
    v_add_f32 v243, v243, v177
    v_add_f32 v241, v241, v170
    v_add_f32 v242, v242, v174
    v_add_f32 v243, v243, v178
    v_add_f32 v241, v241, v171
    v_add_f32 v242, v242, v175
    v_add_f32 v243, v243, v179
    v_add_f32 v241, v241, v180
    v_add_f32 v242, v242, v184
    v_add_f32 v243, v243, v188
    v_add_f32 v241, v241, v181
    v_add_f32 v242, v242, v185
    v_add_f32 v243, v243, v189
    v_add_f32 v241, v241, v182
    v_add_f32 v242, v242, v186
    v_add_f32 v243, v243, v190
    v_add_f32 v241, v241, v183
    v_add_f32 v242, v242, v187
    v_add_f32 v243, v243, v191
    v_cvt_pk_bf16_f32 v144, v144, v145
    v_cvt_pk_bf16_f32 v145, v146, v147
    v_cvt_pk_bf16_f32 v146, v156, v157
    v_cvt_pk_bf16_f32 v147, v158, v159
    v_cvt_pk_bf16_f32 v148, v148, v149
    v_cvt_pk_bf16_f32 v149, v150, v151
    v_cvt_pk_bf16_f32 v150, v160, v161
    v_cvt_pk_bf16_f32 v151, v162, v163
    v_cvt_pk_bf16_f32 v152, v152, v153
    v_cvt_pk_bf16_f32 v153, v154, v155
    v_cvt_pk_bf16_f32 v154, v164, v165
    v_cvt_pk_bf16_f32 v155, v166, v167
    v_cvt_pk_bf16_f32 v168, v168, v169
    v_cvt_pk_bf16_f32 v169, v170, v171
    v_cvt_pk_bf16_f32 v170, v180, v181
    v_cvt_pk_bf16_f32 v171, v182, v183
    v_cvt_pk_bf16_f32 v172, v172, v173
    v_cvt_pk_bf16_f32 v173, v174, v175
    v_cvt_pk_bf16_f32 v174, v184, v185
    v_cvt_pk_bf16_f32 v175, v186, v187
    v_cvt_pk_bf16_f32 v176, v176, v177
    v_cvt_pk_bf16_f32 v177, v178, v179
    v_cvt_pk_bf16_f32 v178, v188, v189
    v_cvt_pk_bf16_f32 v179, v190, v191
    s_waitcnt vmcnt(8)
    s_barrier
    s_add_u32 m0, s29, 32768
    s_add_u32 s32, s35, s53
    s_and_b32 s32, s32, 15
    s_lshl_b32 s32, s32, 14
    s_cmp_ge_u32 s53, 16
    s_cselect_b32 s32, 0x40000000, s32
    s_add_u32 s53, s53, 1
    buffer_load_dwordx4 v236, s[8:11], s32 offen offset:0 nt lds
    buffer_load_dwordx4 v237, s[8:11], s32 offen offset:1024 nt lds
    buffer_load_dwordx4 v236, s[8:11], s32 offen offset:2048 nt lds
    buffer_load_dwordx4 v237, s[8:11], s32 offen offset:3072 nt lds
    ds_read_b64_tr_b16 v[192:193], v228 offset:49152
    ds_read_b64_tr_b16 v[194:195], v228 offset:53248
    ds_read_b64_tr_b16 v[196:197], v229 offset:49152
    ds_read_b64_tr_b16 v[198:199], v229 offset:53248
    ds_read_b64_tr_b16 v[200:201], v230 offset:49152
    ds_read_b64_tr_b16 v[202:203], v230 offset:53248
    ds_read_b64_tr_b16 v[204:205], v231 offset:49152
    ds_read_b64_tr_b16 v[206:207], v231 offset:53248
    ds_read_b64_tr_b16 v[208:209], v232 offset:49152
    ds_read_b64_tr_b16 v[210:211], v232 offset:53248
    ds_read_b64_tr_b16 v[212:213], v233 offset:49152
    ds_read_b64_tr_b16 v[214:215], v233 offset:53248
    ds_read_b64_tr_b16 v[216:217], v234 offset:49152
    ds_read_b64_tr_b16 v[218:219], v234 offset:53248
    s_waitcnt lgkmcnt(12)
    v_mfma_f32_16x16x32_bf16 v[0:3], v[192:195], v[144:147], v[0:3]
    v_mfma_f32_16x16x32_bf16 v[4:7], v[192:195], v[148:151], v[4:7]
    v_mfma_f32_16x16x32_bf16 v[8:11], v[192:195], v[152:155], v[8:11]
    ds_read_b64_tr_b16 v[220:221], v235 offset:49152
    ds_read_b64_tr_b16 v[222:223], v235 offset:53248
    s_waitcnt lgkmcnt(12)
    v_mfma_f32_16x16x32_bf16 v[12:15], v[196:199], v[144:147], v[12:15]
    v_mfma_f32_16x16x32_bf16 v[16:19], v[196:199], v[148:151], v[16:19]
    v_mfma_f32_16x16x32_bf16 v[20:23], v[196:199], v[152:155], v[20:23]
    ds_read_b64_tr_b16 v[192:193], v228 offset:57344
    ds_read_b64_tr_b16 v[194:195], v228 offset:61440
    s_waitcnt lgkmcnt(12)
    v_mfma_f32_16x16x32_bf16 v[24:27], v[200:203], v[144:147], v[24:27]
    v_mfma_f32_16x16x32_bf16 v[28:31], v[200:203], v[148:151], v[28:31]
    v_mfma_f32_16x16x32_bf16 v[32:35], v[200:203], v[152:155], v[32:35]
    ds_read_b64_tr_b16 v[196:197], v229 offset:57344
    ds_read_b64_tr_b16 v[198:199], v229 offset:61440
    s_waitcnt lgkmcnt(12)
    v_mfma_f32_16x16x32_bf16 v[36:39], v[204:207], v[144:147], v[36:39]
    v_mfma_f32_16x16x32_bf16 v[40:43], v[204:207], v[148:151], v[40:43]
    v_mfma_f32_16x16x32_bf16 v[44:47], v[204:207], v[152:155], v[44:47]
    ds_read_b64_tr_b16 v[200:201], v230 offset:57344
    ds_read_b64_tr_b16 v[202:203], v230 offset:61440
    s_waitcnt lgkmcnt(12)
    v_mfma_f32_16x16x32_bf16 v[48:51], v[208:211], v[144:147], v[48:51]
    v_mfma_f32_16x16x32_bf16 v[52:55], v[208:211], v[148:151], v[52:55]
    v_mfma_f32_16x16x32_bf16 v[56:59], v[208:211], v[152:155], v[56:59]
    ds_read_b64_tr_b16 v[204:205], v231 offset:57344
    ds_read_b64_tr_b16 v[206:207], v231 offset:61440
    s_waitcnt lgkmcnt(12)
    v_mfma_f32_16x16x32_bf16 v[60:63], v[212:215], v[144:147], v[60:63]
    v_mfma_f32_16x16x32_bf16 v[64:67], v[212:215], v[148:151], v[64:67]
    v_mfma_f32_16x16x32_bf16 v[68:71], v[212:215], v[152:155], v[68:71]
    ds_read_b64_tr_b16 v[208:209], v232 offset:57344
    ds_read_b64_tr_b16 v[210:211], v232 offset:61440
    s_waitcnt lgkmcnt(12)
    v_mfma_f32_16x16x32_bf16 v[72:75], v[216:219], v[144:147], v[72:75]
    v_mfma_f32_16x16x32_bf16 v[76:79], v[216:219], v[148:151], v[76:79]
    v_mfma_f32_16x16x32_bf16 v[80:83], v[216:219], v[152:155], v[80:83]
    ds_read_b64_tr_b16 v[212:213], v233 offset:57344
    ds_read_b64_tr_b16 v[214:215], v233 offset:61440
    s_waitcnt lgkmcnt(12)
    v_mfma_f32_16x16x32_bf16 v[84:87], v[220:223], v[144:147], v[84:87]
    v_mfma_f32_16x16x32_bf16 v[88:91], v[220:223], v[148:151], v[88:91]
    v_mfma_f32_16x16x32_bf16 v[92:95], v[220:223], v[152:155], v[92:95]
    ds_read_b64_tr_b16 v[216:217], v234 offset:57344
    ds_read_b64_tr_b16 v[218:219], v234 offset:61440
    s_waitcnt lgkmcnt(12)
    v_mfma_f32_16x16x32_bf16 v[0:3], v[192:195], v[168:171], v[0:3]
    v_mfma_f32_16x16x32_bf16 v[4:7], v[192:195], v[172:175], v[4:7]
    v_mfma_f32_16x16x32_bf16 v[8:11], v[192:195], v[176:179], v[8:11]
    ds_read_b64_tr_b16 v[220:221], v235 offset:57344
    ds_read_b64_tr_b16 v[222:223], v235 offset:61440
    s_waitcnt lgkmcnt(12)
    v_mfma_f32_16x16x32_bf16 v[12:15], v[196:199], v[168:171], v[12:15]
    v_mfma_f32_16x16x32_bf16 v[16:19], v[196:199], v[172:175], v[16:19]
    v_mfma_f32_16x16x32_bf16 v[20:23], v[196:199], v[176:179], v[20:23]
    s_waitcnt lgkmcnt(10)
    v_mfma_f32_16x16x32_bf16 v[24:27], v[200:203], v[168:171], v[24:27]
    v_mfma_f32_16x16x32_bf16 v[28:31], v[200:203], v[172:175], v[28:31]
    v_mfma_f32_16x16x32_bf16 v[32:35], v[200:203], v[176:179], v[32:35]
    s_waitcnt lgkmcnt(8)
    v_mfma_f32_16x16x32_bf16 v[36:39], v[204:207], v[168:171], v[36:39]
    v_mfma_f32_16x16x32_bf16 v[40:43], v[204:207], v[172:175], v[40:43]
    v_mfma_f32_16x16x32_bf16 v[44:47], v[204:207], v[176:179], v[44:47]
    s_waitcnt lgkmcnt(6)
    v_mfma_f32_16x16x32_bf16 v[48:51], v[208:211], v[168:171], v[48:51]
    v_mfma_f32_16x16x32_bf16 v[52:55], v[208:211], v[172:175], v[52:55]
    v_mfma_f32_16x16x32_bf16 v[56:59], v[208:211], v[176:179], v[56:59]
    s_waitcnt lgkmcnt(4)
    v_mfma_f32_16x16x32_bf16 v[60:63], v[212:215], v[168:171], v[60:63]
    v_mfma_f32_16x16x32_bf16 v[64:67], v[212:215], v[172:175], v[64:67]
    v_mfma_f32_16x16x32_bf16 v[68:71], v[212:215], v[176:179], v[68:71]
    s_waitcnt lgkmcnt(2)
    v_mfma_f32_16x16x32_bf16 v[72:75], v[216:219], v[168:171], v[72:75]
    v_mfma_f32_16x16x32_bf16 v[76:79], v[216:219], v[172:175], v[76:79]
    v_mfma_f32_16x16x32_bf16 v[80:83], v[216:219], v[176:179], v[80:83]
    s_waitcnt lgkmcnt(0)
    v_mfma_f32_16x16x32_bf16 v[84:87], v[220:223], v[168:171], v[84:87]
    v_mfma_f32_16x16x32_bf16 v[88:91], v[220:223], v[172:175], v[88:91]
    v_mfma_f32_16x16x32_bf16 v[92:95], v[220:223], v[176:179], v[92:95]
    s_sub_u32 s34, s34, 1
    s_cmp_lg_u32 s34, 0
    s_cbranch_scc1 L_attn_loop
    s_nop 7
    v_mov_b32 v244, v241
    v_mov_b32 v245, v242
    v_mov_b32 v246, v243
    v_permlane32_swap_b32 v241, v244
    v_permlane32_swap_b32 v242, v245
    v_permlane32_swap_b32 v243, v246
    v_add_f32 v241, v241, v244
    v_add_f32 v242, v242, v245
    v_add_f32 v243, v243, v246
    v_mov_b32 v244, v241
    v_mov_b32 v245, v242
    v_mov_b32 v246, v243
    v_permlane16_swap_b32 v241, v244
    v_permlane16_swap_b32 v242, v245
    v_permlane16_swap_b32 v243, v246
    v_add_f32 v241, v241, v244
    v_add_f32 v242, v242, v245
    v_add_f32 v243, v243, v246
    v_rcp_f32 v241, v241
    v_rcp_f32 v242, v242
    v_rcp_f32 v243, v243
    v_mul_f32 v0, v0, v241
    v_mul_f32 v1, v1, v241
    v_mul_f32 v2, v2, v241
    v_mul_f32 v3, v3, v241
    v_mul_f32 v4, v4, v242
    v_mul_f32 v5, v5, v242
    v_mul_f32 v6, v6, v242
    v_mul_f32 v7, v7, v242
    v_mul_f32 v8, v8, v243
    v_mul_f32 v9, v9, v243
    v_mul_f32 v10, v10, v243
    v_mul_f32 v11, v11, v243
    v_mul_f32 v12, v12, v241
    v_mul_f32 v13, v13, v241
    v_mul_f32 v14, v14, v241
    v_mul_f32 v15, v15, v241
    v_mul_f32 v16, v16, v242
    v_mul_f32 v17, v17, v242
    v_mul_f32 v18, v18, v242
    v_mul_f32 v19, v19, v242
    v_mul_f32 v20, v20, v243
    v_mul_f32 v21, v21, v243
    v_mul_f32 v22, v22, v243
    v_mul_f32 v23, v23, v243
    v_mul_f32 v24, v24, v241
    v_mul_f32 v25, v25, v241
    v_mul_f32 v26, v26, v241
    v_mul_f32 v27, v27, v241
    v_mul_f32 v28, v28, v242
    v_mul_f32 v29, v29, v242
    v_mul_f32 v30, v30, v242
    v_mul_f32 v31, v31, v242
    v_mul_f32 v32, v32, v243
    v_mul_f32 v33, v33, v243
    v_mul_f32 v34, v34, v243
    v_mul_f32 v35, v35, v243
    v_mul_f32 v36, v36, v241
    v_mul_f32 v37, v37, v241
    v_mul_f32 v38, v38, v241
    v_mul_f32 v39, v39, v241
    v_mul_f32 v40, v40, v242
    v_mul_f32 v41, v41, v242
    v_mul_f32 v42, v42, v242
    v_mul_f32 v43, v43, v242
    v_mul_f32 v44, v44, v243
    v_mul_f32 v45, v45, v243
    v_mul_f32 v46, v46, v243
    v_mul_f32 v47, v47, v243
    v_mul_f32 v48, v48, v241
    v_mul_f32 v49, v49, v241
    v_mul_f32 v50, v50, v241
    v_mul_f32 v51, v51, v241
    v_mul_f32 v52, v52, v242
    v_mul_f32 v53, v53, v242
    v_mul_f32 v54, v54, v242
    v_mul_f32 v55, v55, v242
    v_mul_f32 v56, v56, v243
    v_mul_f32 v57, v57, v243
    v_mul_f32 v58, v58, v243
    v_mul_f32 v59, v59, v243
    v_mul_f32 v60, v60, v241
    v_mul_f32 v61, v61, v241
    v_mul_f32 v62, v62, v241
    v_mul_f32 v63, v63, v241
    v_mul_f32 v64, v64, v242
    v_mul_f32 v65, v65, v242
    v_mul_f32 v66, v66, v242
    v_mul_f32 v67, v67, v242
    v_mul_f32 v68, v68, v243
    v_mul_f32 v69, v69, v243
    v_mul_f32 v70, v70, v243
    v_mul_f32 v71, v71, v243
    v_mul_f32 v72, v72, v241
    v_mul_f32 v73, v73, v241
    v_mul_f32 v74, v74, v241
    v_mul_f32 v75, v75, v241
    v_mul_f32 v76, v76, v242
    v_mul_f32 v77, v77, v242
    v_mul_f32 v78, v78, v242
    v_mul_f32 v79, v79, v242
    v_mul_f32 v80, v80, v243
    v_mul_f32 v81, v81, v243
    v_mul_f32 v82, v82, v243
    v_mul_f32 v83, v83, v243
    v_mul_f32 v84, v84, v241
    v_mul_f32 v85, v85, v241
    v_mul_f32 v86, v86, v241
    v_mul_f32 v87, v87, v241
    v_mul_f32 v88, v88, v242
    v_mul_f32 v89, v89, v242
    v_mul_f32 v90, v90, v242
    v_mul_f32 v91, v91, v242
    v_mul_f32 v92, v92, v243
    v_mul_f32 v93, v93, v243
    v_mul_f32 v94, v94, v243
    v_mul_f32 v95, v95, v243
    v_mbcnt_lo_u32_b32 v244, -1, 0
    v_mbcnt_hi_u32_b32 v244, -1, v244
    s_mul_i32 s32, s28, 393216
    v_lshlrev_b32 v248, 4, v244
    v_add_u32 v248, s32, v248
    v_add_u32 v249, 0x20000, v248
    v_add_u32 v250, 0x40000, v248
    v_cvt_pk_bf16_f32 v96, v0, v1
    v_cvt_pk_bf16_f32 v97, v2, v3
    v_cvt_pk_bf16_f32 v98, v12, v13
    v_cvt_pk_bf16_f32 v99, v14, v15
    buffer_store_dwordx4 v[96:99], v248, s[24:27], 0 offen offset:0
    v_cvt_pk_bf16_f32 v100, v4, v5
    v_cvt_pk_bf16_f32 v101, v6, v7
    v_cvt_pk_bf16_f32 v102, v16, v17
    v_cvt_pk_bf16_f32 v103, v18, v19
    buffer_store_dwordx4 v[100:103], v249, s[24:27], 0 offen offset:0
    v_cvt_pk_bf16_f32 v104, v8, v9
    v_cvt_pk_bf16_f32 v105, v10, v11
    v_cvt_pk_bf16_f32 v106, v20, v21
    v_cvt_pk_bf16_f32 v107, v22, v23
    buffer_store_dwordx4 v[104:107], v250, s[24:27], 0 offen offset:0
    v_cvt_pk_bf16_f32 v108, v24, v25
    v_cvt_pk_bf16_f32 v109, v26, v27
    v_cvt_pk_bf16_f32 v110, v36, v37
    v_cvt_pk_bf16_f32 v111, v38, v39
    buffer_store_dwordx4 v[108:111], v248, s[24:27], 0 offen offset:1024
    v_cvt_pk_bf16_f32 v112, v28, v29
    v_cvt_pk_bf16_f32 v113, v30, v31
    v_cvt_pk_bf16_f32 v114, v40, v41
    v_cvt_pk_bf16_f32 v115, v42, v43
    buffer_store_dwordx4 v[112:115], v249, s[24:27], 0 offen offset:1024
    v_cvt_pk_bf16_f32 v116, v32, v33
    v_cvt_pk_bf16_f32 v117, v34, v35
    v_cvt_pk_bf16_f32 v118, v44, v45
    v_cvt_pk_bf16_f32 v119, v46, v47
    buffer_store_dwordx4 v[116:119], v250, s[24:27], 0 offen offset:1024
    v_cvt_pk_bf16_f32 v120, v48, v49
    v_cvt_pk_bf16_f32 v121, v50, v51
    v_cvt_pk_bf16_f32 v122, v60, v61
    v_cvt_pk_bf16_f32 v123, v62, v63
    buffer_store_dwordx4 v[120:123], v248, s[24:27], 0 offen offset:2048
    v_cvt_pk_bf16_f32 v124, v52, v53
    v_cvt_pk_bf16_f32 v125, v54, v55
    v_cvt_pk_bf16_f32 v126, v64, v65
    v_cvt_pk_bf16_f32 v127, v66, v67
    buffer_store_dwordx4 v[124:127], v249, s[24:27], 0 offen offset:2048
    v_cvt_pk_bf16_f32 v128, v56, v57
    v_cvt_pk_bf16_f32 v129, v58, v59
    v_cvt_pk_bf16_f32 v130, v68, v69
    v_cvt_pk_bf16_f32 v131, v70, v71
    buffer_store_dwordx4 v[128:131], v250, s[24:27], 0 offen offset:2048
    v_cvt_pk_bf16_f32 v132, v72, v73
    v_cvt_pk_bf16_f32 v133, v74, v75
    v_cvt_pk_bf16_f32 v134, v84, v85
    v_cvt_pk_bf16_f32 v135, v86, v87
    buffer_store_dwordx4 v[132:135], v248, s[24:27], 0 offen offset:3072
    v_cvt_pk_bf16_f32 v136, v76, v77
    v_cvt_pk_bf16_f32 v137, v78, v79
    v_cvt_pk_bf16_f32 v138, v88, v89
    v_cvt_pk_bf16_f32 v139, v90, v91
    buffer_store_dwordx4 v[136:139], v249, s[24:27], 0 offen offset:3072
    v_cvt_pk_bf16_f32 v140, v80, v81
    v_cvt_pk_bf16_f32 v141, v82, v83
    v_cvt_pk_bf16_f32 v142, v92, v93
    v_cvt_pk_bf16_f32 v143, v94, v95
    buffer_store_dwordx4 v[140:143], v250, s[24:27], 0 offen offset:3072
L_attn_end:
    s_endpgm
.globl oproj_kernel
.p2align 8
.type oproj_kernel,@function
oproj_kernel:
    s_cmp_ge_u32 s2, 256
    s_cbranch_scc1 L_oproj_end
    s_and_b32 s40, s2, 3
    s_lshr_b32 s41, s2, 2
    s_and_b32 s41, s41, 7
    s_lshr_b32 s42, s2, 5
    s_and_b32 s42, s42, 1
    s_lshr_b32 s43, s2, 6
    s_mul_i32 s3, s42, 40
    s_add_u32 s4, s0, s3
    s_addc_u32 s5, s1, 0
    s_load_dwordx2 s[36:37], s[4:5], 32
    s_load_dwordx2 s[44:45], s[0:1], 96
    v_lshrrev_b32 v1, 6, v0
    s_nop 0
    v_readfirstlane_b32 s28, v1
    s_waitcnt lgkmcnt(0)
    s_lshl_b32 s46, s40, 8
    s_lshl_b32 s47, s43, 20
    s_add_u32 s46, s46, s47
    s_add_u32 s8, s36, s46
    s_addc_u32 s9, s37, 0
    s_mov_b32 s10, 1047808
    s_mov_b32 s11, 0x00020000
    s_mul_i32 s46, s42, 12582912
    s_mul_i32 s47, s41, 1572864
    s_add_u32 s46, s46, s47
    s_lshl_b32 s47, s43, 15
    s_add_u32 s46, s46, s47
    s_add_u32 s12, s44, s46
    s_addc_u32 s13, s45, 0
    s_mov_b32 s14, 1474560
    s_mov_b32 s15, 0x00020000
    s_lshl_b32 s46, s43, 1
    s_add_u32 s46, s46, s42
    s_mul_i32 s46, s46, 1536
    s_mul_i32 s47, s41, 192
    s_add_u32 s46, s46, s47
    s_lshl_b32 s46, s46, 11
    s_lshl_b32 s47, s40, 9
    s_add_u32 s46, s46, s47
    s_add_u32 s46, s46, 0x2000000
    s_add_u32 s16, s44, s46
    s_addc_u32 s17, s45, 0
    s_mov_b32 s18, 391680
    s_mov_b32 s19, 0x00020000
    s_lshl_b32 s29, s28, 12
    s_lshr_b32 s58, s2, 3
    s_and_b32 s58, s58, 15
    v_mbcnt_lo_u32_b32 v244, -1, 0
    v_mbcnt_hi_u32_b32 v244, -1, v244
    v_lshrrev_b32 v245, 4, v244
    v_and_b32 v246, 15, v244
    v_and_b32 v247, 7, v246
    v_lshlrev_b32 v247, 1, v247
    v_add_u32 v248, 0, v245
    v_xor_b32 v248, v248, v247
    v_lshlrev_b32 v248, 4, v248
    v_lshl_add_u32 v224, v246, 8, v248
    v_add_u32 v248, 4, v245
    v_xor_b32 v248, v248, v247
    v_lshlrev_b32 v248, 4, v248
    v_lshl_add_u32 v225, v246, 8, v248
    v_add_u32 v248, 8, v245
    v_xor_b32 v248, v248, v247
    v_lshlrev_b32 v248, 4, v248
    v_lshl_add_u32 v226, v246, 8, v248
    v_add_u32 v248, 12, v245
    v_xor_b32 v248, v248, v247
    v_lshlrev_b32 v248, 4, v248
    v_lshl_add_u32 v227, v246, 8, v248
    v_lshrrev_b32 v247, 2, v246
    v_lshl_add_u32 v247, v245, 2, v247
    v_and_b32 v248, 7, v247
    v_lshlrev_b32 v248, 1, v248
    v_and_b32 v249, 3, v246
    v_lshrrev_b32 v250, 1, v249
    v_and_b32 v249, 1, v249
    v_lshlrev_b32 v249, 3, v249
    v_lshl_add_u32 v249, v247, 8, v249
    v_add_u32 v251, 0, v250
    v_xor_b32 v251, v251, v248
    v_lshl_add_u32 v228, v251, 4, v249
    v_add_u32 v251, 2, v250
    v_xor_b32 v251, v251, v248
    v_lshl_add_u32 v229, v251, 4, v249
    v_add_u32 v251, 4, v250
    v_xor_b32 v251, v251, v248
    v_lshl_add_u32 v230, v251, 4, v249
    v_add_u32 v251, 6, v250
    v_xor_b32 v251, v251, v248
    v_lshl_add_u32 v231, v251, 4, v249
    v_add_u32 v251, 8, v250
    v_xor_b32 v251, v251, v248
    v_lshl_add_u32 v232, v251, 4, v249
    v_add_u32 v251, 10, v250
    v_xor_b32 v251, v251, v248
    v_lshl_add_u32 v233, v251, 4, v249
    v_add_u32 v251, 12, v250
    v_xor_b32 v251, v251, v248
    v_lshl_add_u32 v234, v251, 4, v249
    v_add_u32 v251, 14, v250
    v_xor_b32 v251, v251, v248
    v_lshl_add_u32 v235, v251, 4, v249
    v_mbcnt_lo_u32_b32 v244, -1, 0
    v_mbcnt_hi_u32_b32 v244, -1, v244
    v_lshrrev_b32 v245, 4, v244
    v_and_b32 v246, 15, v244
    v_lshlrev_b32 v247, 1, v245
    v_xor_b32 v248, v246, v247
    v_lshlrev_b32 v248, 4, v248
    v_add_u32 v247, 8, v247
    v_xor_b32 v249, v246, v247
    v_lshlrev_b32 v249, 4, v249
    v_lshl_add_u32 v245, s28, 4, v245
    v_lshlrev_b32 v245, 10, v245
    v_add_u32 v236, v245, v248
    v_add_u32 v237, v245, v249
    v_mbcnt_lo_u32_b32 v244, -1, 0
    v_mbcnt_hi_u32_b32 v244, -1, v244
    s_mul_i32 s32, s28, 393216
    v_lshlrev_b32 v244, 4, v244
    v_add_u32 v252, s32, v244
    s_mul_i32 s32, s28, 6144
    v_add_u32 v253, s32, v244
    v_add_u32 v254, 81920, v253
    v_add_u32 v100, 81920, v228
    v_add_u32 v101, 81920, v229
    v_add_u32 v102, 81920, v230
    v_add_u32 v103, 81920, v231
    v_add_u32 v104, 81920, v232
    v_add_u32 v105, 81920, v233
    v_add_u32 v106, 81920, v234
    v_add_u32 v107, 81920, v235
    s_mul_i32 s33, s28, 6144
    v_mov_b32 v0, 0
    v_mov_b32 v1, 0
    v_mov_b32 v2, 0
    v_mov_b32 v3, 0
    v_mov_b32 v4, 0
    v_mov_b32 v5, 0
    v_mov_b32 v6, 0
    v_mov_b32 v7, 0
    v_mov_b32 v8, 0
    v_mov_b32 v9, 0
    v_mov_b32 v10, 0
    v_mov_b32 v11, 0
    v_mov_b32 v12, 0
    v_mov_b32 v13, 0
    v_mov_b32 v14, 0
    v_mov_b32 v15, 0
    v_mov_b32 v16, 0
    v_mov_b32 v17, 0
    v_mov_b32 v18, 0
    v_mov_b32 v19, 0
    v_mov_b32 v20, 0
    v_mov_b32 v21, 0
    v_mov_b32 v22, 0
    v_mov_b32 v23, 0
    v_mov_b32 v24, 0
    v_mov_b32 v25, 0
    v_mov_b32 v26, 0
    v_mov_b32 v27, 0
    v_mov_b32 v28, 0
    v_mov_b32 v29, 0
    v_mov_b32 v30, 0
    v_mov_b32 v31, 0
    v_mov_b32 v32, 0
    v_mov_b32 v33, 0
    v_mov_b32 v34, 0
    v_mov_b32 v35, 0
    v_mov_b32 v36, 0
    v_mov_b32 v37, 0
    v_mov_b32 v38, 0
    v_mov_b32 v39, 0
    v_mov_b32 v40, 0
    v_mov_b32 v41, 0
    v_mov_b32 v42, 0
    v_mov_b32 v43, 0
    v_mov_b32 v44, 0
    v_mov_b32 v45, 0
    v_mov_b32 v46, 0
    v_mov_b32 v47, 0
    v_mov_b32 v48, 0
    v_mov_b32 v49, 0
    v_mov_b32 v50, 0
    v_mov_b32 v51, 0
    v_mov_b32 v52, 0
    v_mov_b32 v53, 0
    v_mov_b32 v54, 0
    v_mov_b32 v55, 0
    v_mov_b32 v56, 0
    v_mov_b32 v57, 0
    v_mov_b32 v58, 0
    v_mov_b32 v59, 0
    v_mov_b32 v60, 0
    v_mov_b32 v61, 0
    v_mov_b32 v62, 0
    v_mov_b32 v63, 0
    v_mov_b32 v64, 0
    v_mov_b32 v65, 0
    v_mov_b32 v66, 0
    v_mov_b32 v67, 0
    v_mov_b32 v68, 0
    v_mov_b32 v69, 0
    v_mov_b32 v70, 0
    v_mov_b32 v71, 0
    v_mov_b32 v72, 0
    v_mov_b32 v73, 0
    v_mov_b32 v74, 0
    v_mov_b32 v75, 0
    v_mov_b32 v76, 0
    v_mov_b32 v77, 0
    v_mov_b32 v78, 0
    v_mov_b32 v79, 0
    v_mov_b32 v80, 0
    v_mov_b32 v81, 0
    v_mov_b32 v82, 0
    v_mov_b32 v83, 0
    v_mov_b32 v84, 0
    v_mov_b32 v85, 0
    v_mov_b32 v86, 0
    v_mov_b32 v87, 0
    v_mov_b32 v88, 0
    v_mov_b32 v89, 0
    v_mov_b32 v90, 0
    v_mov_b32 v91, 0
    v_mov_b32 v92, 0
    v_mov_b32 v93, 0
    v_mov_b32 v94, 0
    v_mov_b32 v95, 0
    s_add_u32 s57, s58, 0
    s_and_b32 s57, s57, 15
    s_lshl_b32 s59, s57, 11
    s_lshl_b32 s57, s57, 16
    s_add_u32 m0, s29, 0
    s_add_u32 s32, s57, 0
    buffer_load_dwordx4 v236, s[8:11], s32 offen offset:0 lds
    s_add_u32 s32, s57, 3072
    buffer_load_dwordx4 v237, s[8:11], s32 offen offset:1024 lds
    s_add_u32 s32, s57, 6144
    buffer_load_dwordx4 v236, s[8:11], s32 offen offset:2048 lds
    s_add_u32 s32, s57, 9216
    buffer_load_dwordx4 v237, s[8:11], s32 offen offset:3072 lds
    s_add_u32 m0, s33, 16384
    s_add_u32 s32, s59, 0
    buffer_load_dwordx4 v252, s[12:15], s32 offen lds
    buffer_load_dwordx4 v252, s[12:15], s32 offen offset:1024 lds
    s_add_u32 m0, s33, 18432
    s_add_u32 s32, s59, 131072
    buffer_load_dwordx4 v252, s[12:15], s32 offen lds
    buffer_load_dwordx4 v252, s[12:15], s32 offen offset:1024 lds
    s_add_u32 m0, s33, 20480
    s_add_u32 s32, s59, 262144
    buffer_load_dwordx4 v252, s[12:15], s32 offen lds
    buffer_load_dwordx4 v252, s[12:15], s32 offen offset:1024 lds
    s_add_u32 s57, s58, 1
    s_and_b32 s57, s57, 15
    s_lshl_b32 s59, s57, 11
    s_lshl_b32 s57, s57, 16
    s_add_u32 m0, s29, 40960
    s_add_u32 s32, s57, 0
    buffer_load_dwordx4 v236, s[8:11], s32 offen offset:0 lds
    s_add_u32 s32, s57, 3072
    buffer_load_dwordx4 v237, s[8:11], s32 offen offset:1024 lds
    s_add_u32 s32, s57, 6144
    buffer_load_dwordx4 v236, s[8:11], s32 offen offset:2048 lds
    s_add_u32 s32, s57, 9216
    buffer_load_dwordx4 v237, s[8:11], s32 offen offset:3072 lds
    s_add_u32 m0, s33, 57344
    s_add_u32 s32, s59, 0
    buffer_load_dwordx4 v252, s[12:15], s32 offen lds
    buffer_load_dwordx4 v252, s[12:15], s32 offen offset:1024 lds
    s_add_u32 m0, s33, 59392
    s_add_u32 s32, s59, 131072
    buffer_load_dwordx4 v252, s[12:15], s32 offen lds
    buffer_load_dwordx4 v252, s[12:15], s32 offen offset:1024 lds
    s_add_u32 m0, s33, 61440
    s_add_u32 s32, s59, 262144
    buffer_load_dwordx4 v252, s[12:15], s32 offen lds
    buffer_load_dwordx4 v252, s[12:15], s32 offen offset:1024 lds
    s_add_u32 s57, s58, 2
    s_and_b32 s57, s57, 15
    s_lshl_b32 s59, s57, 11
    s_lshl_b32 s57, s57, 16
    s_add_u32 m0, s29, 81920
    s_add_u32 s32, s57, 0
    buffer_load_dwordx4 v236, s[8:11], s32 offen offset:0 lds
    s_add_u32 s32, s57, 3072
    buffer_load_dwordx4 v237, s[8:11], s32 offen offset:1024 lds
    s_add_u32 s32, s57, 6144
    buffer_load_dwordx4 v236, s[8:11], s32 offen offset:2048 lds
    s_add_u32 s32, s57, 9216
    buffer_load_dwordx4 v237, s[8:11], s32 offen offset:3072 lds
    s_add_u32 m0, s33, 98304
    s_add_u32 s32, s59, 0
    buffer_load_dwordx4 v252, s[12:15], s32 offen lds
    buffer_load_dwordx4 v252, s[12:15], s32 offen offset:1024 lds
    s_add_u32 m0, s33, 100352
    s_add_u32 s32, s59, 131072
    buffer_load_dwordx4 v252, s[12:15], s32 offen lds
    buffer_load_dwordx4 v252, s[12:15], s32 offen offset:1024 lds
    s_add_u32 m0, s33, 102400
    s_add_u32 s32, s59, 262144
    buffer_load_dwordx4 v252, s[12:15], s32 offen lds
    buffer_load_dwordx4 v252, s[12:15], s32 offen offset:1024 lds
    s_waitcnt vmcnt(20)
    s_barrier
    ds_read_b128 v[110:113], v253 offset:16384
    ds_read_b128 v[122:125], v253 offset:17408
    ds_read_b128 v[114:117], v253 offset:18432
    ds_read_b128 v[126:129], v253 offset:19456
    ds_read_b128 v[118:121], v253 offset:20480
    ds_read_b128 v[130:133], v253 offset:21504
    s_add_u32 s57, s58, 3
    s_and_b32 s57, s57, 15
    s_lshl_b32 s59, s57, 11
    s_lshl_b32 s57, s57, 16
    s_add_u32 m0, s29, 122880
    s_add_u32 s32, s57, 0
    buffer_load_dwordx4 v236, s[8:11], s32 offen offset:0 lds
    s_add_u32 s32, s57, 3072
    buffer_load_dwordx4 v237, s[8:11], s32 offen offset:1024 lds
    s_add_u32 s32, s57, 6144
    buffer_load_dwordx4 v236, s[8:11], s32 offen offset:2048 lds
    s_add_u32 s32, s57, 9216
    buffer_load_dwordx4 v237, s[8:11], s32 offen offset:3072 lds
    s_add_u32 m0, s33, 139264
    s_add_u32 s32, s59, 0
    buffer_load_dwordx4 v252, s[12:15], s32 offen lds
    buffer_load_dwordx4 v252, s[12:15], s32 offen offset:1024 lds
    s_add_u32 m0, s33, 141312
    s_add_u32 s32, s59, 131072
    buffer_load_dwordx4 v252, s[12:15], s32 offen lds
    buffer_load_dwordx4 v252, s[12:15], s32 offen offset:1024 lds
    s_add_u32 m0, s33, 143360
    s_add_u32 s32, s59, 262144
    buffer_load_dwordx4 v252, s[12:15], s32 offen lds
    buffer_load_dwordx4 v252, s[12:15], s32 offen offset:1024 lds
    s_waitcnt lgkmcnt(0)
    ds_read_b64_tr_b16 v[192:193], v228 offset:0
    ds_read_b64_tr_b16 v[194:195], v228 offset:4096
    ds_read_b64_tr_b16 v[196:197], v229 offset:0
    ds_read_b64_tr_b16 v[198:199], v229 offset:4096
    ds_read_b64_tr_b16 v[200:201], v230 offset:0
    ds_read_b64_tr_b16 v[202:203], v230 offset:4096
    ds_read_b64_tr_b16 v[204:205], v231 offset:0
    ds_read_b64_tr_b16 v[206:207], v231 offset:4096
    ds_read_b64_tr_b16 v[208:209], v232 offset:0
    ds_read_b64_tr_b16 v[210:211], v232 offset:4096
    ds_read_b64_tr_b16 v[212:213], v233 offset:0
    ds_read_b64_tr_b16 v[214:215], v233 offset:4096
    ds_read_b64_tr_b16 v[216:217], v234 offset:0
    ds_read_b64_tr_b16 v[218:219], v234 offset:4096
    s_waitcnt lgkmcnt(12)
    v_mfma_f32_16x16x32_bf16 v[0:3], v[192:195], v[110:113], v[0:3]
    v_mfma_f32_16x16x32_bf16 v[4:7], v[192:195], v[114:117], v[4:7]
    v_mfma_f32_16x16x32_bf16 v[8:11], v[192:195], v[118:121], v[8:11]
    ds_read_b64_tr_b16 v[220:221], v235 offset:0
    ds_read_b64_tr_b16 v[222:223], v235 offset:4096
    s_waitcnt lgkmcnt(12)
    v_mfma_f32_16x16x32_bf16 v[12:15], v[196:199], v[110:113], v[12:15]
    v_mfma_f32_16x16x32_bf16 v[16:19], v[196:199], v[114:117], v[16:19]
    v_mfma_f32_16x16x32_bf16 v[20:23], v[196:199], v[118:121], v[20:23]
    ds_read_b64_tr_b16 v[192:193], v228 offset:8192
    ds_read_b64_tr_b16 v[194:195], v228 offset:12288
    s_waitcnt lgkmcnt(12)
    v_mfma_f32_16x16x32_bf16 v[24:27], v[200:203], v[110:113], v[24:27]
    v_mfma_f32_16x16x32_bf16 v[28:31], v[200:203], v[114:117], v[28:31]
    v_mfma_f32_16x16x32_bf16 v[32:35], v[200:203], v[118:121], v[32:35]
    ds_read_b64_tr_b16 v[196:197], v229 offset:8192
    ds_read_b64_tr_b16 v[198:199], v229 offset:12288
    s_waitcnt lgkmcnt(12)
    v_mfma_f32_16x16x32_bf16 v[36:39], v[204:207], v[110:113], v[36:39]
    v_mfma_f32_16x16x32_bf16 v[40:43], v[204:207], v[114:117], v[40:43]
    v_mfma_f32_16x16x32_bf16 v[44:47], v[204:207], v[118:121], v[44:47]
    ds_read_b64_tr_b16 v[200:201], v230 offset:8192
    ds_read_b64_tr_b16 v[202:203], v230 offset:12288
    s_waitcnt lgkmcnt(12)
    v_mfma_f32_16x16x32_bf16 v[48:51], v[208:211], v[110:113], v[48:51]
    v_mfma_f32_16x16x32_bf16 v[52:55], v[208:211], v[114:117], v[52:55]
    v_mfma_f32_16x16x32_bf16 v[56:59], v[208:211], v[118:121], v[56:59]
    ds_read_b64_tr_b16 v[204:205], v231 offset:8192
    ds_read_b64_tr_b16 v[206:207], v231 offset:12288
    s_waitcnt lgkmcnt(12)
    v_mfma_f32_16x16x32_bf16 v[60:63], v[212:215], v[110:113], v[60:63]
    v_mfma_f32_16x16x32_bf16 v[64:67], v[212:215], v[114:117], v[64:67]
    v_mfma_f32_16x16x32_bf16 v[68:71], v[212:215], v[118:121], v[68:71]
    ds_read_b64_tr_b16 v[208:209], v232 offset:8192
    ds_read_b64_tr_b16 v[210:211], v232 offset:12288
    s_waitcnt lgkmcnt(12)
    v_mfma_f32_16x16x32_bf16 v[72:75], v[216:219], v[110:113], v[72:75]
    v_mfma_f32_16x16x32_bf16 v[76:79], v[216:219], v[114:117], v[76:79]
    v_mfma_f32_16x16x32_bf16 v[80:83], v[216:219], v[118:121], v[80:83]
    ds_read_b64_tr_b16 v[212:213], v233 offset:8192
    ds_read_b64_tr_b16 v[214:215], v233 offset:12288
    s_waitcnt lgkmcnt(12)
    v_mfma_f32_16x16x32_bf16 v[84:87], v[220:223], v[110:113], v[84:87]
    v_mfma_f32_16x16x32_bf16 v[88:91], v[220:223], v[114:117], v[88:91]
    v_mfma_f32_16x16x32_bf16 v[92:95], v[220:223], v[118:121], v[92:95]
    ds_read_b64_tr_b16 v[216:217], v234 offset:8192
    ds_read_b64_tr_b16 v[218:219], v234 offset:12288
    s_waitcnt lgkmcnt(12)
    v_mfma_f32_16x16x32_bf16 v[0:3], v[192:195], v[122:125], v[0:3]
    v_mfma_f32_16x16x32_bf16 v[4:7], v[192:195], v[126:129], v[4:7]
    v_mfma_f32_16x16x32_bf16 v[8:11], v[192:195], v[130:133], v[8:11]
    ds_read_b64_tr_b16 v[220:221], v235 offset:8192
    ds_read_b64_tr_b16 v[222:223], v235 offset:12288
    s_waitcnt lgkmcnt(12)
    v_mfma_f32_16x16x32_bf16 v[12:15], v[196:199], v[122:125], v[12:15]
    v_mfma_f32_16x16x32_bf16 v[16:19], v[196:199], v[126:129], v[16:19]
    v_mfma_f32_16x16x32_bf16 v[20:23], v[196:199], v[130:133], v[20:23]
    s_waitcnt lgkmcnt(10)
    v_mfma_f32_16x16x32_bf16 v[24:27], v[200:203], v[122:125], v[24:27]
    v_mfma_f32_16x16x32_bf16 v[28:31], v[200:203], v[126:129], v[28:31]
    v_mfma_f32_16x16x32_bf16 v[32:35], v[200:203], v[130:133], v[32:35]
    s_waitcnt lgkmcnt(8)
    v_mfma_f32_16x16x32_bf16 v[36:39], v[204:207], v[122:125], v[36:39]
    v_mfma_f32_16x16x32_bf16 v[40:43], v[204:207], v[126:129], v[40:43]
    v_mfma_f32_16x16x32_bf16 v[44:47], v[204:207], v[130:133], v[44:47]
    s_waitcnt lgkmcnt(6)
    v_mfma_f32_16x16x32_bf16 v[48:51], v[208:211], v[122:125], v[48:51]
    v_mfma_f32_16x16x32_bf16 v[52:55], v[208:211], v[126:129], v[52:55]
    v_mfma_f32_16x16x32_bf16 v[56:59], v[208:211], v[130:133], v[56:59]
    s_waitcnt lgkmcnt(4)
    v_mfma_f32_16x16x32_bf16 v[60:63], v[212:215], v[122:125], v[60:63]
    v_mfma_f32_16x16x32_bf16 v[64:67], v[212:215], v[126:129], v[64:67]
    v_mfma_f32_16x16x32_bf16 v[68:71], v[212:215], v[130:133], v[68:71]
    s_waitcnt lgkmcnt(2)
    v_mfma_f32_16x16x32_bf16 v[72:75], v[216:219], v[122:125], v[72:75]
    v_mfma_f32_16x16x32_bf16 v[76:79], v[216:219], v[126:129], v[76:79]
    v_mfma_f32_16x16x32_bf16 v[80:83], v[216:219], v[130:133], v[80:83]
    s_waitcnt lgkmcnt(0)
    v_mfma_f32_16x16x32_bf16 v[84:87], v[220:223], v[122:125], v[84:87]
    v_mfma_f32_16x16x32_bf16 v[88:91], v[220:223], v[126:129], v[88:91]
    v_mfma_f32_16x16x32_bf16 v[92:95], v[220:223], v[130:133], v[92:95]
    s_waitcnt vmcnt(20)
    s_barrier
    ds_read_b128 v[110:113], v253 offset:57344
    ds_read_b128 v[122:125], v253 offset:58368
    ds_read_b128 v[114:117], v253 offset:59392
    ds_read_b128 v[126:129], v253 offset:60416
    ds_read_b128 v[118:121], v253 offset:61440
    ds_read_b128 v[130:133], v253 offset:62464
    s_add_u32 s57, s58, 4
    s_and_b32 s57, s57, 15
    s_lshl_b32 s59, s57, 11
    s_lshl_b32 s57, s57, 16
    s_add_u32 m0, s29, 0
    s_add_u32 s32, s57, 0
    buffer_load_dwordx4 v236, s[8:11], s32 offen offset:0 lds
    s_add_u32 s32, s57, 3072
    buffer_load_dwordx4 v237, s[8:11], s32 offen offset:1024 lds
    s_add_u32 s32, s57, 6144
    buffer_load_dwordx4 v236, s[8:11], s32 offen offset:2048 lds
    s_add_u32 s32, s57, 9216
    buffer_load_dwordx4 v237, s[8:11], s32 offen offset:3072 lds
    s_add_u32 m0, s33, 16384
    s_add_u32 s32, s59, 0
    buffer_load_dwordx4 v252, s[12:15], s32 offen lds
    buffer_load_dwordx4 v252, s[12:15], s32 offen offset:1024 lds
    s_add_u32 m0, s33, 18432
    s_add_u32 s32, s59, 131072
    buffer_load_dwordx4 v252, s[12:15], s32 offen lds
    buffer_load_dwordx4 v252, s[12:15], s32 offen offset:1024 lds
    s_add_u32 m0, s33, 20480
    s_add_u32 s32, s59, 262144
    buffer_load_dwordx4 v252, s[12:15], s32 offen lds
    buffer_load_dwordx4 v252, s[12:15], s32 offen offset:1024 lds
    s_waitcnt lgkmcnt(0)
    ds_read_b64_tr_b16 v[192:193], v228 offset:40960
    ds_read_b64_tr_b16 v[194:195], v228 offset:45056
    ds_read_b64_tr_b16 v[196:197], v229 offset:40960
    ds_read_b64_tr_b16 v[198:199], v229 offset:45056
    ds_read_b64_tr_b16 v[200:201], v230 offset:40960
    ds_read_b64_tr_b16 v[202:203], v230 offset:45056
    ds_read_b64_tr_b16 v[204:205], v231 offset:40960
    ds_read_b64_tr_b16 v[206:207], v231 offset:45056
    ds_read_b64_tr_b16 v[208:209], v232 offset:40960
    ds_read_b64_tr_b16 v[210:211], v232 offset:45056
    ds_read_b64_tr_b16 v[212:213], v233 offset:40960
    ds_read_b64_tr_b16 v[214:215], v233 offset:45056
    ds_read_b64_tr_b16 v[216:217], v234 offset:40960
    ds_read_b64_tr_b16 v[218:219], v234 offset:45056
    s_waitcnt lgkmcnt(12)
    v_mfma_f32_16x16x32_bf16 v[0:3], v[192:195], v[110:113], v[0:3]
    v_mfma_f32_16x16x32_bf16 v[4:7], v[192:195], v[114:117], v[4:7]
    v_mfma_f32_16x16x32_bf16 v[8:11], v[192:195], v[118:121], v[8:11]
    ds_read_b64_tr_b16 v[220:221], v235 offset:40960
    ds_read_b64_tr_b16 v[222:223], v235 offset:45056
    s_waitcnt lgkmcnt(12)
    v_mfma_f32_16x16x32_bf16 v[12:15], v[196:199], v[110:113], v[12:15]
    v_mfma_f32_16x16x32_bf16 v[16:19], v[196:199], v[114:117], v[16:19]
    v_mfma_f32_16x16x32_bf16 v[20:23], v[196:199], v[118:121], v[20:23]
    ds_read_b64_tr_b16 v[192:193], v228 offset:49152
    ds_read_b64_tr_b16 v[194:195], v228 offset:53248
    s_waitcnt lgkmcnt(12)
    v_mfma_f32_16x16x32_bf16 v[24:27], v[200:203], v[110:113], v[24:27]
    v_mfma_f32_16x16x32_bf16 v[28:31], v[200:203], v[114:117], v[28:31]
    v_mfma_f32_16x16x32_bf16 v[32:35], v[200:203], v[118:121], v[32:35]
    ds_read_b64_tr_b16 v[196:197], v229 offset:49152
    ds_read_b64_tr_b16 v[198:199], v229 offset:53248
    s_waitcnt lgkmcnt(12)
    v_mfma_f32_16x16x32_bf16 v[36:39], v[204:207], v[110:113], v[36:39]
    v_mfma_f32_16x16x32_bf16 v[40:43], v[204:207], v[114:117], v[40:43]
    v_mfma_f32_16x16x32_bf16 v[44:47], v[204:207], v[118:121], v[44:47]
    ds_read_b64_tr_b16 v[200:201], v230 offset:49152
    ds_read_b64_tr_b16 v[202:203], v230 offset:53248
    s_waitcnt lgkmcnt(12)
    v_mfma_f32_16x16x32_bf16 v[48:51], v[208:211], v[110:113], v[48:51]
    v_mfma_f32_16x16x32_bf16 v[52:55], v[208:211], v[114:117], v[52:55]
    v_mfma_f32_16x16x32_bf16 v[56:59], v[208:211], v[118:121], v[56:59]
    ds_read_b64_tr_b16 v[204:205], v231 offset:49152
    ds_read_b64_tr_b16 v[206:207], v231 offset:53248
    s_waitcnt lgkmcnt(12)
    v_mfma_f32_16x16x32_bf16 v[60:63], v[212:215], v[110:113], v[60:63]
    v_mfma_f32_16x16x32_bf16 v[64:67], v[212:215], v[114:117], v[64:67]
    v_mfma_f32_16x16x32_bf16 v[68:71], v[212:215], v[118:121], v[68:71]
    ds_read_b64_tr_b16 v[208:209], v232 offset:49152
    ds_read_b64_tr_b16 v[210:211], v232 offset:53248
    s_waitcnt lgkmcnt(12)
    v_mfma_f32_16x16x32_bf16 v[72:75], v[216:219], v[110:113], v[72:75]
    v_mfma_f32_16x16x32_bf16 v[76:79], v[216:219], v[114:117], v[76:79]
    v_mfma_f32_16x16x32_bf16 v[80:83], v[216:219], v[118:121], v[80:83]
    ds_read_b64_tr_b16 v[212:213], v233 offset:49152
    ds_read_b64_tr_b16 v[214:215], v233 offset:53248
    s_waitcnt lgkmcnt(12)
    v_mfma_f32_16x16x32_bf16 v[84:87], v[220:223], v[110:113], v[84:87]
    v_mfma_f32_16x16x32_bf16 v[88:91], v[220:223], v[114:117], v[88:91]
    v_mfma_f32_16x16x32_bf16 v[92:95], v[220:223], v[118:121], v[92:95]
    ds_read_b64_tr_b16 v[216:217], v234 offset:49152
    ds_read_b64_tr_b16 v[218:219], v234 offset:53248
    s_waitcnt lgkmcnt(12)
    v_mfma_f32_16x16x32_bf16 v[0:3], v[192:195], v[122:125], v[0:3]
    v_mfma_f32_16x16x32_bf16 v[4:7], v[192:195], v[126:129], v[4:7]
    v_mfma_f32_16x16x32_bf16 v[8:11], v[192:195], v[130:133], v[8:11]
    ds_read_b64_tr_b16 v[220:221], v235 offset:49152
    ds_read_b64_tr_b16 v[222:223], v235 offset:53248
    s_waitcnt lgkmcnt(12)
    v_mfma_f32_16x16x32_bf16 v[12:15], v[196:199], v[122:125], v[12:15]
    v_mfma_f32_16x16x32_bf16 v[16:19], v[196:199], v[126:129], v[16:19]
    v_mfma_f32_16x16x32_bf16 v[20:23], v[196:199], v[130:133], v[20:23]
    s_waitcnt lgkmcnt(10)
    v_mfma_f32_16x16x32_bf16 v[24:27], v[200:203], v[122:125], v[24:27]
    v_mfma_f32_16x16x32_bf16 v[28:31], v[200:203], v[126:129], v[28:31]
    v_mfma_f32_16x16x32_bf16 v[32:35], v[200:203], v[130:133], v[32:35]
    s_waitcnt lgkmcnt(8)
    v_mfma_f32_16x16x32_bf16 v[36:39], v[204:207], v[122:125], v[36:39]
    v_mfma_f32_16x16x32_bf16 v[40:43], v[204:207], v[126:129], v[40:43]
    v_mfma_f32_16x16x32_bf16 v[44:47], v[204:207], v[130:133], v[44:47]
    s_waitcnt lgkmcnt(6)
    v_mfma_f32_16x16x32_bf16 v[48:51], v[208:211], v[122:125], v[48:51]
    v_mfma_f32_16x16x32_bf16 v[52:55], v[208:211], v[126:129], v[52:55]
    v_mfma_f32_16x16x32_bf16 v[56:59], v[208:211], v[130:133], v[56:59]
    s_waitcnt lgkmcnt(4)
    v_mfma_f32_16x16x32_bf16 v[60:63], v[212:215], v[122:125], v[60:63]
    v_mfma_f32_16x16x32_bf16 v[64:67], v[212:215], v[126:129], v[64:67]
    v_mfma_f32_16x16x32_bf16 v[68:71], v[212:215], v[130:133], v[68:71]
    s_waitcnt lgkmcnt(2)
    v_mfma_f32_16x16x32_bf16 v[72:75], v[216:219], v[122:125], v[72:75]
    v_mfma_f32_16x16x32_bf16 v[76:79], v[216:219], v[126:129], v[76:79]
    v_mfma_f32_16x16x32_bf16 v[80:83], v[216:219], v[130:133], v[80:83]
    s_waitcnt lgkmcnt(0)
    v_mfma_f32_16x16x32_bf16 v[84:87], v[220:223], v[122:125], v[84:87]
    v_mfma_f32_16x16x32_bf16 v[88:91], v[220:223], v[126:129], v[88:91]
    v_mfma_f32_16x16x32_bf16 v[92:95], v[220:223], v[130:133], v[92:95]
    s_waitcnt vmcnt(20)
    s_barrier
    ds_read_b128 v[110:113], v254 offset:16384
    ds_read_b128 v[122:125], v254 offset:17408
    ds_read_b128 v[114:117], v254 offset:18432
    ds_read_b128 v[126:129], v254 offset:19456
    ds_read_b128 v[118:121], v254 offset:20480
    ds_read_b128 v[130:133], v254 offset:21504
    s_add_u32 s57, s58, 5
    s_and_b32 s57, s57, 15
    s_lshl_b32 s59, s57, 11
    s_lshl_b32 s57, s57, 16
    s_add_u32 m0, s29, 40960
    s_add_u32 s32, s57, 0
    buffer_load_dwordx4 v236, s[8:11], s32 offen offset:0 lds
    s_add_u32 s32, s57, 3072
    buffer_load_dwordx4 v237, s[8:11], s32 offen offset:1024 lds
    s_add_u32 s32, s57, 6144
    buffer_load_dwordx4 v236, s[8:11], s32 offen offset:2048 lds
    s_add_u32 s32, s57, 9216
    buffer_load_dwordx4 v237, s[8:11], s32 offen offset:3072 lds
    s_add_u32 m0, s33, 57344
    s_add_u32 s32, s59, 0
    buffer_load_dwordx4 v252, s[12:15], s32 offen lds
    buffer_load_dwordx4 v252, s[12:15], s32 offen offset:1024 lds
    s_add_u32 m0, s33, 59392
    s_add_u32 s32, s59, 131072
    buffer_load_dwordx4 v252, s[12:15], s32 offen lds
    buffer_load_dwordx4 v252, s[12:15], s32 offen offset:1024 lds
    s_add_u32 m0, s33, 61440
    s_add_u32 s32, s59, 262144
    buffer_load_dwordx4 v252, s[12:15], s32 offen lds
    buffer_load_dwordx4 v252, s[12:15], s32 offen offset:1024 lds
    s_waitcnt lgkmcnt(0)
    ds_read_b64_tr_b16 v[192:193], v100 offset:0
    ds_read_b64_tr_b16 v[194:195], v100 offset:4096
    ds_read_b64_tr_b16 v[196:197], v101 offset:0
    ds_read_b64_tr_b16 v[198:199], v101 offset:4096
    ds_read_b64_tr_b16 v[200:201], v102 offset:0
    ds_read_b64_tr_b16 v[202:203], v102 offset:4096
    ds_read_b64_tr_b16 v[204:205], v103 offset:0
    ds_read_b64_tr_b16 v[206:207], v103 offset:4096
    ds_read_b64_tr_b16 v[208:209], v104 offset:0
    ds_read_b64_tr_b16 v[210:211], v104 offset:4096
    ds_read_b64_tr_b16 v[212:213], v105 offset:0
    ds_read_b64_tr_b16 v[214:215], v105 offset:4096
    ds_read_b64_tr_b16 v[216:217], v106 offset:0
    ds_read_b64_tr_b16 v[218:219], v106 offset:4096
    s_waitcnt lgkmcnt(12)
    v_mfma_f32_16x16x32_bf16 v[0:3], v[192:195], v[110:113], v[0:3]
    v_mfma_f32_16x16x32_bf16 v[4:7], v[192:195], v[114:117], v[4:7]
    v_mfma_f32_16x16x32_bf16 v[8:11], v[192:195], v[118:121], v[8:11]
    ds_read_b64_tr_b16 v[220:221], v107 offset:0
    ds_read_b64_tr_b16 v[222:223], v107 offset:4096
    s_waitcnt lgkmcnt(12)
    v_mfma_f32_16x16x32_bf16 v[12:15], v[196:199], v[110:113], v[12:15]
    v_mfma_f32_16x16x32_bf16 v[16:19], v[196:199], v[114:117], v[16:19]
    v_mfma_f32_16x16x32_bf16 v[20:23], v[196:199], v[118:121], v[20:23]
    ds_read_b64_tr_b16 v[192:193], v100 offset:8192
    ds_read_b64_tr_b16 v[194:195], v100 offset:12288
    s_waitcnt lgkmcnt(12)
    v_mfma_f32_16x16x32_bf16 v[24:27], v[200:203], v[110:113], v[24:27]
    v_mfma_f32_16x16x32_bf16 v[28:31], v[200:203], v[114:117], v[28:31]
    v_mfma_f32_16x16x32_bf16 v[32:35], v[200:203], v[118:121], v[32:35]
    ds_read_b64_tr_b16 v[196:197], v101 offset:8192
    ds_read_b64_tr_b16 v[198:199], v101 offset:12288
    s_waitcnt lgkmcnt(12)
    v_mfma_f32_16x16x32_bf16 v[36:39], v[204:207], v[110:113], v[36:39]
    v_mfma_f32_16x16x32_bf16 v[40:43], v[204:207], v[114:117], v[40:43]
    v_mfma_f32_16x16x32_bf16 v[44:47], v[204:207], v[118:121], v[44:47]
    ds_read_b64_tr_b16 v[200:201], v102 offset:8192
    ds_read_b64_tr_b16 v[202:203], v102 offset:12288
    s_waitcnt lgkmcnt(12)
    v_mfma_f32_16x16x32_bf16 v[48:51], v[208:211], v[110:113], v[48:51]
    v_mfma_f32_16x16x32_bf16 v[52:55], v[208:211], v[114:117], v[52:55]
    v_mfma_f32_16x16x32_bf16 v[56:59], v[208:211], v[118:121], v[56:59]
    ds_read_b64_tr_b16 v[204:205], v103 offset:8192
    ds_read_b64_tr_b16 v[206:207], v103 offset:12288
    s_waitcnt lgkmcnt(12)
    v_mfma_f32_16x16x32_bf16 v[60:63], v[212:215], v[110:113], v[60:63]
    v_mfma_f32_16x16x32_bf16 v[64:67], v[212:215], v[114:117], v[64:67]
    v_mfma_f32_16x16x32_bf16 v[68:71], v[212:215], v[118:121], v[68:71]
    ds_read_b64_tr_b16 v[208:209], v104 offset:8192
    ds_read_b64_tr_b16 v[210:211], v104 offset:12288
    s_waitcnt lgkmcnt(12)
    v_mfma_f32_16x16x32_bf16 v[72:75], v[216:219], v[110:113], v[72:75]
    v_mfma_f32_16x16x32_bf16 v[76:79], v[216:219], v[114:117], v[76:79]
    v_mfma_f32_16x16x32_bf16 v[80:83], v[216:219], v[118:121], v[80:83]
    ds_read_b64_tr_b16 v[212:213], v105 offset:8192
    ds_read_b64_tr_b16 v[214:215], v105 offset:12288
    s_waitcnt lgkmcnt(12)
    v_mfma_f32_16x16x32_bf16 v[84:87], v[220:223], v[110:113], v[84:87]
    v_mfma_f32_16x16x32_bf16 v[88:91], v[220:223], v[114:117], v[88:91]
    v_mfma_f32_16x16x32_bf16 v[92:95], v[220:223], v[118:121], v[92:95]
    ds_read_b64_tr_b16 v[216:217], v106 offset:8192
    ds_read_b64_tr_b16 v[218:219], v106 offset:12288
    s_waitcnt lgkmcnt(12)
    v_mfma_f32_16x16x32_bf16 v[0:3], v[192:195], v[122:125], v[0:3]
    v_mfma_f32_16x16x32_bf16 v[4:7], v[192:195], v[126:129], v[4:7]
    v_mfma_f32_16x16x32_bf16 v[8:11], v[192:195], v[130:133], v[8:11]
    ds_read_b64_tr_b16 v[220:221], v107 offset:8192
    ds_read_b64_tr_b16 v[222:223], v107 offset:12288
    s_waitcnt lgkmcnt(12)
    v_mfma_f32_16x16x32_bf16 v[12:15], v[196:199], v[122:125], v[12:15]
    v_mfma_f32_16x16x32_bf16 v[16:19], v[196:199], v[126:129], v[16:19]
    v_mfma_f32_16x16x32_bf16 v[20:23], v[196:199], v[130:133], v[20:23]
    s_waitcnt lgkmcnt(10)
    v_mfma_f32_16x16x32_bf16 v[24:27], v[200:203], v[122:125], v[24:27]
    v_mfma_f32_16x16x32_bf16 v[28:31], v[200:203], v[126:129], v[28:31]
    v_mfma_f32_16x16x32_bf16 v[32:35], v[200:203], v[130:133], v[32:35]
    s_waitcnt lgkmcnt(8)
    v_mfma_f32_16x16x32_bf16 v[36:39], v[204:207], v[122:125], v[36:39]
    v_mfma_f32_16x16x32_bf16 v[40:43], v[204:207], v[126:129], v[40:43]
    v_mfma_f32_16x16x32_bf16 v[44:47], v[204:207], v[130:133], v[44:47]
    s_waitcnt lgkmcnt(6)
    v_mfma_f32_16x16x32_bf16 v[48:51], v[208:211], v[122:125], v[48:51]
    v_mfma_f32_16x16x32_bf16 v[52:55], v[208:211], v[126:129], v[52:55]
    v_mfma_f32_16x16x32_bf16 v[56:59], v[208:211], v[130:133], v[56:59]
    s_waitcnt lgkmcnt(4)
    v_mfma_f32_16x16x32_bf16 v[60:63], v[212:215], v[122:125], v[60:63]
    v_mfma_f32_16x16x32_bf16 v[64:67], v[212:215], v[126:129], v[64:67]
    v_mfma_f32_16x16x32_bf16 v[68:71], v[212:215], v[130:133], v[68:71]
    s_waitcnt lgkmcnt(2)
    v_mfma_f32_16x16x32_bf16 v[72:75], v[216:219], v[122:125], v[72:75]
    v_mfma_f32_16x16x32_bf16 v[76:79], v[216:219], v[126:129], v[76:79]
    v_mfma_f32_16x16x32_bf16 v[80:83], v[216:219], v[130:133], v[80:83]
    s_waitcnt lgkmcnt(0)
    v_mfma_f32_16x16x32_bf16 v[84:87], v[220:223], v[122:125], v[84:87]
    v_mfma_f32_16x16x32_bf16 v[88:91], v[220:223], v[126:129], v[88:91]
    v_mfma_f32_16x16x32_bf16 v[92:95], v[220:223], v[130:133], v[92:95]
    s_waitcnt vmcnt(20)
    s_barrier
    ds_read_b128 v[110:113], v254 offset:57344
    ds_read_b128 v[122:125], v254 offset:58368
    ds_read_b128 v[114:117], v254 offset:59392
    ds_read_b128 v[126:129], v254 offset:60416
    ds_read_b128 v[118:121], v254 offset:61440
    ds_read_b128 v[130:133], v254 offset:62464
    s_add_u32 s57, s58, 6
    s_and_b32 s57, s57, 15
    s_lshl_b32 s59, s57, 11
    s_lshl_b32 s57, s57, 16
    s_add_u32 m0, s29, 81920
    s_add_u32 s32, s57, 0
    buffer_load_dwordx4 v236, s[8:11], s32 offen offset:0 lds
    s_add_u32 s32, s57, 3072
    buffer_load_dwordx4 v237, s[8:11], s32 offen offset:1024 lds
    s_add_u32 s32, s57, 6144
    buffer_load_dwordx4 v236, s[8:11], s32 offen offset:2048 lds
    s_add_u32 s32, s57, 9216
    buffer_load_dwordx4 v237, s[8:11], s32 offen offset:3072 lds
    s_add_u32 m0, s33, 98304
    s_add_u32 s32, s59, 0
    buffer_load_dwordx4 v252, s[12:15], s32 offen lds
    buffer_load_dwordx4 v252, s[12:15], s32 offen offset:1024 lds
    s_add_u32 m0, s33, 100352
    s_add_u32 s32, s59, 131072
    buffer_load_dwordx4 v252, s[12:15], s32 offen lds
    buffer_load_dwordx4 v252, s[12:15], s32 offen offset:1024 lds
    s_add_u32 m0, s33, 102400
    s_add_u32 s32, s59, 262144
    buffer_load_dwordx4 v252, s[12:15], s32 offen lds
    buffer_load_dwordx4 v252, s[12:15], s32 offen offset:1024 lds
    s_waitcnt lgkmcnt(0)
    ds_read_b64_tr_b16 v[192:193], v100 offset:40960
    ds_read_b64_tr_b16 v[194:195], v100 offset:45056
    ds_read_b64_tr_b16 v[196:197], v101 offset:40960
    ds_read_b64_tr_b16 v[198:199], v101 offset:45056
    ds_read_b64_tr_b16 v[200:201], v102 offset:40960
    ds_read_b64_tr_b16 v[202:203], v102 offset:45056
    ds_read_b64_tr_b16 v[204:205], v103 offset:40960
    ds_read_b64_tr_b16 v[206:207], v103 offset:45056
    ds_read_b64_tr_b16 v[208:209], v104 offset:40960
    ds_read_b64_tr_b16 v[210:211], v104 offset:45056
    ds_read_b64_tr_b16 v[212:213], v105 offset:40960
    ds_read_b64_tr_b16 v[214:215], v105 offset:45056
    ds_read_b64_tr_b16 v[216:217], v106 offset:40960
    ds_read_b64_tr_b16 v[218:219], v106 offset:45056
    s_waitcnt lgkmcnt(12)
    v_mfma_f32_16x16x32_bf16 v[0:3], v[192:195], v[110:113], v[0:3]
    v_mfma_f32_16x16x32_bf16 v[4:7], v[192:195], v[114:117], v[4:7]
    v_mfma_f32_16x16x32_bf16 v[8:11], v[192:195], v[118:121], v[8:11]
    ds_read_b64_tr_b16 v[220:221], v107 offset:40960
    ds_read_b64_tr_b16 v[222:223], v107 offset:45056
    s_waitcnt lgkmcnt(12)
    v_mfma_f32_16x16x32_bf16 v[12:15], v[196:199], v[110:113], v[12:15]
    v_mfma_f32_16x16x32_bf16 v[16:19], v[196:199], v[114:117], v[16:19]
    v_mfma_f32_16x16x32_bf16 v[20:23], v[196:199], v[118:121], v[20:23]
    ds_read_b64_tr_b16 v[192:193], v100 offset:49152
    ds_read_b64_tr_b16 v[194:195], v100 offset:53248
    s_waitcnt lgkmcnt(12)
    v_mfma_f32_16x16x32_bf16 v[24:27], v[200:203], v[110:113], v[24:27]
    v_mfma_f32_16x16x32_bf16 v[28:31], v[200:203], v[114:117], v[28:31]
    v_mfma_f32_16x16x32_bf16 v[32:35], v[200:203], v[118:121], v[32:35]
    ds_read_b64_tr_b16 v[196:197], v101 offset:49152
    ds_read_b64_tr_b16 v[198:199], v101 offset:53248
    s_waitcnt lgkmcnt(12)
    v_mfma_f32_16x16x32_bf16 v[36:39], v[204:207], v[110:113], v[36:39]
    v_mfma_f32_16x16x32_bf16 v[40:43], v[204:207], v[114:117], v[40:43]
    v_mfma_f32_16x16x32_bf16 v[44:47], v[204:207], v[118:121], v[44:47]
    ds_read_b64_tr_b16 v[200:201], v102 offset:49152
    ds_read_b64_tr_b16 v[202:203], v102 offset:53248
    s_waitcnt lgkmcnt(12)
    v_mfma_f32_16x16x32_bf16 v[48:51], v[208:211], v[110:113], v[48:51]
    v_mfma_f32_16x16x32_bf16 v[52:55], v[208:211], v[114:117], v[52:55]
    v_mfma_f32_16x16x32_bf16 v[56:59], v[208:211], v[118:121], v[56:59]
    ds_read_b64_tr_b16 v[204:205], v103 offset:49152
    ds_read_b64_tr_b16 v[206:207], v103 offset:53248
    s_waitcnt lgkmcnt(12)
    v_mfma_f32_16x16x32_bf16 v[60:63], v[212:215], v[110:113], v[60:63]
    v_mfma_f32_16x16x32_bf16 v[64:67], v[212:215], v[114:117], v[64:67]
    v_mfma_f32_16x16x32_bf16 v[68:71], v[212:215], v[118:121], v[68:71]
    ds_read_b64_tr_b16 v[208:209], v104 offset:49152
    ds_read_b64_tr_b16 v[210:211], v104 offset:53248
    s_waitcnt lgkmcnt(12)
    v_mfma_f32_16x16x32_bf16 v[72:75], v[216:219], v[110:113], v[72:75]
    v_mfma_f32_16x16x32_bf16 v[76:79], v[216:219], v[114:117], v[76:79]
    v_mfma_f32_16x16x32_bf16 v[80:83], v[216:219], v[118:121], v[80:83]
    ds_read_b64_tr_b16 v[212:213], v105 offset:49152
    ds_read_b64_tr_b16 v[214:215], v105 offset:53248
    s_waitcnt lgkmcnt(12)
    v_mfma_f32_16x16x32_bf16 v[84:87], v[220:223], v[110:113], v[84:87]
    v_mfma_f32_16x16x32_bf16 v[88:91], v[220:223], v[114:117], v[88:91]
    v_mfma_f32_16x16x32_bf16 v[92:95], v[220:223], v[118:121], v[92:95]
    ds_read_b64_tr_b16 v[216:217], v106 offset:49152
    ds_read_b64_tr_b16 v[218:219], v106 offset:53248
    s_waitcnt lgkmcnt(12)
    v_mfma_f32_16x16x32_bf16 v[0:3], v[192:195], v[122:125], v[0:3]
    v_mfma_f32_16x16x32_bf16 v[4:7], v[192:195], v[126:129], v[4:7]
    v_mfma_f32_16x16x32_bf16 v[8:11], v[192:195], v[130:133], v[8:11]
    ds_read_b64_tr_b16 v[220:221], v107 offset:49152
    ds_read_b64_tr_b16 v[222:223], v107 offset:53248
    s_waitcnt lgkmcnt(12)
    v_mfma_f32_16x16x32_bf16 v[12:15], v[196:199], v[122:125], v[12:15]
    v_mfma_f32_16x16x32_bf16 v[16:19], v[196:199], v[126:129], v[16:19]
    v_mfma_f32_16x16x32_bf16 v[20:23], v[196:199], v[130:133], v[20:23]
    s_waitcnt lgkmcnt(10)
    v_mfma_f32_16x16x32_bf16 v[24:27], v[200:203], v[122:125], v[24:27]
    v_mfma_f32_16x16x32_bf16 v[28:31], v[200:203], v[126:129], v[28:31]
    v_mfma_f32_16x16x32_bf16 v[32:35], v[200:203], v[130:133], v[32:35]
    s_waitcnt lgkmcnt(8)
    v_mfma_f32_16x16x32_bf16 v[36:39], v[204:207], v[122:125], v[36:39]
    v_mfma_f32_16x16x32_bf16 v[40:43], v[204:207], v[126:129], v[40:43]
    v_mfma_f32_16x16x32_bf16 v[44:47], v[204:207], v[130:133], v[44:47]
    s_waitcnt lgkmcnt(6)
    v_mfma_f32_16x16x32_bf16 v[48:51], v[208:211], v[122:125], v[48:51]
    v_mfma_f32_16x16x32_bf16 v[52:55], v[208:211], v[126:129], v[52:55]
    v_mfma_f32_16x16x32_bf16 v[56:59], v[208:211], v[130:133], v[56:59]
    s_waitcnt lgkmcnt(4)
    v_mfma_f32_16x16x32_bf16 v[60:63], v[212:215], v[122:125], v[60:63]
    v_mfma_f32_16x16x32_bf16 v[64:67], v[212:215], v[126:129], v[64:67]
    v_mfma_f32_16x16x32_bf16 v[68:71], v[212:215], v[130:133], v[68:71]
    s_waitcnt lgkmcnt(2)
    v_mfma_f32_16x16x32_bf16 v[72:75], v[216:219], v[122:125], v[72:75]
    v_mfma_f32_16x16x32_bf16 v[76:79], v[216:219], v[126:129], v[76:79]
    v_mfma_f32_16x16x32_bf16 v[80:83], v[216:219], v[130:133], v[80:83]
    s_waitcnt lgkmcnt(0)
    v_mfma_f32_16x16x32_bf16 v[84:87], v[220:223], v[122:125], v[84:87]
    v_mfma_f32_16x16x32_bf16 v[88:91], v[220:223], v[126:129], v[88:91]
    v_mfma_f32_16x16x32_bf16 v[92:95], v[220:223], v[130:133], v[92:95]
    s_waitcnt vmcnt(20)
    s_barrier
    ds_read_b128 v[110:113], v253 offset:16384
    ds_read_b128 v[122:125], v253 offset:17408
    ds_read_b128 v[114:117], v253 offset:18432
    ds_read_b128 v[126:129], v253 offset:19456
    ds_read_b128 v[118:121], v253 offset:20480
    ds_read_b128 v[130:133], v253 offset:21504
    s_add_u32 s57, s58, 7
    s_and_b32 s57, s57, 15
    s_lshl_b32 s59, s57, 11
    s_lshl_b32 s57, s57, 16
    s_add_u32 m0, s29, 122880
    s_add_u32 s32, s57, 0
    buffer_load_dwordx4 v236, s[8:11], s32 offen offset:0 lds
    s_add_u32 s32, s57, 3072
    buffer_load_dwordx4 v237, s[8:11], s32 offen offset:1024 lds
    s_add_u32 s32, s57, 6144
    buffer_load_dwordx4 v236, s[8:11], s32 offen offset:2048 lds
    s_add_u32 s32, s57, 9216
    buffer_load_dwordx4 v237, s[8:11], s32 offen offset:3072 lds
    s_add_u32 m0, s33, 139264
    s_add_u32 s32, s59, 0
    buffer_load_dwordx4 v252, s[12:15], s32 offen lds
    buffer_load_dwordx4 v252, s[12:15], s32 offen offset:1024 lds
    s_add_u32 m0, s33, 141312
    s_add_u32 s32, s59, 131072
    buffer_load_dwordx4 v252, s[12:15], s32 offen lds
    buffer_load_dwordx4 v252, s[12:15], s32 offen offset:1024 lds
    s_add_u32 m0, s33, 143360
    s_add_u32 s32, s59, 262144
    buffer_load_dwordx4 v252, s[12:15], s32 offen lds
    buffer_load_dwordx4 v252, s[12:15], s32 offen offset:1024 lds
    s_waitcnt lgkmcnt(0)
    ds_read_b64_tr_b16 v[192:193], v228 offset:0
    ds_read_b64_tr_b16 v[194:195], v228 offset:4096
    ds_read_b64_tr_b16 v[196:197], v229 offset:0
    ds_read_b64_tr_b16 v[198:199], v229 offset:4096
    ds_read_b64_tr_b16 v[200:201], v230 offset:0
    ds_read_b64_tr_b16 v[202:203], v230 offset:4096
    ds_read_b64_tr_b16 v[204:205], v231 offset:0
    ds_read_b64_tr_b16 v[206:207], v231 offset:4096
    ds_read_b64_tr_b16 v[208:209], v232 offset:0
    ds_read_b64_tr_b16 v[210:211], v232 offset:4096
    ds_read_b64_tr_b16 v[212:213], v233 offset:0
    ds_read_b64_tr_b16 v[214:215], v233 offset:4096
    ds_read_b64_tr_b16 v[216:217], v234 offset:0
    ds_read_b64_tr_b16 v[218:219], v234 offset:4096
    s_waitcnt lgkmcnt(12)
    v_mfma_f32_16x16x32_bf16 v[0:3], v[192:195], v[110:113], v[0:3]
    v_mfma_f32_16x16x32_bf16 v[4:7], v[192:195], v[114:117], v[4:7]
    v_mfma_f32_16x16x32_bf16 v[8:11], v[192:195], v[118:121], v[8:11]
    ds_read_b64_tr_b16 v[220:221], v235 offset:0
    ds_read_b64_tr_b16 v[222:223], v235 offset:4096
    s_waitcnt lgkmcnt(12)
    v_mfma_f32_16x16x32_bf16 v[12:15], v[196:199], v[110:113], v[12:15]
    v_mfma_f32_16x16x32_bf16 v[16:19], v[196:199], v[114:117], v[16:19]
    v_mfma_f32_16x16x32_bf16 v[20:23], v[196:199], v[118:121], v[20:23]
    ds_read_b64_tr_b16 v[192:193], v228 offset:8192
    ds_read_b64_tr_b16 v[194:195], v228 offset:12288
    s_waitcnt lgkmcnt(12)
    v_mfma_f32_16x16x32_bf16 v[24:27], v[200:203], v[110:113], v[24:27]
    v_mfma_f32_16x16x32_bf16 v[28:31], v[200:203], v[114:117], v[28:31]
    v_mfma_f32_16x16x32_bf16 v[32:35], v[200:203], v[118:121], v[32:35]
    ds_read_b64_tr_b16 v[196:197], v229 offset:8192
    ds_read_b64_tr_b16 v[198:199], v229 offset:12288
    s_waitcnt lgkmcnt(12)
    v_mfma_f32_16x16x32_bf16 v[36:39], v[204:207], v[110:113], v[36:39]
    v_mfma_f32_16x16x32_bf16 v[40:43], v[204:207], v[114:117], v[40:43]
    v_mfma_f32_16x16x32_bf16 v[44:47], v[204:207], v[118:121], v[44:47]
    ds_read_b64_tr_b16 v[200:201], v230 offset:8192
    ds_read_b64_tr_b16 v[202:203], v230 offset:12288
    s_waitcnt lgkmcnt(12)
    v_mfma_f32_16x16x32_bf16 v[48:51], v[208:211], v[110:113], v[48:51]
    v_mfma_f32_16x16x32_bf16 v[52:55], v[208:211], v[114:117], v[52:55]
    v_mfma_f32_16x16x32_bf16 v[56:59], v[208:211], v[118:121], v[56:59]
    ds_read_b64_tr_b16 v[204:205], v231 offset:8192
    ds_read_b64_tr_b16 v[206:207], v231 offset:12288
    s_waitcnt lgkmcnt(12)
    v_mfma_f32_16x16x32_bf16 v[60:63], v[212:215], v[110:113], v[60:63]
    v_mfma_f32_16x16x32_bf16 v[64:67], v[212:215], v[114:117], v[64:67]
    v_mfma_f32_16x16x32_bf16 v[68:71], v[212:215], v[118:121], v[68:71]
    ds_read_b64_tr_b16 v[208:209], v232 offset:8192
    ds_read_b64_tr_b16 v[210:211], v232 offset:12288
    s_waitcnt lgkmcnt(12)
    v_mfma_f32_16x16x32_bf16 v[72:75], v[216:219], v[110:113], v[72:75]
    v_mfma_f32_16x16x32_bf16 v[76:79], v[216:219], v[114:117], v[76:79]
    v_mfma_f32_16x16x32_bf16 v[80:83], v[216:219], v[118:121], v[80:83]
    ds_read_b64_tr_b16 v[212:213], v233 offset:8192
    ds_read_b64_tr_b16 v[214:215], v233 offset:12288
    s_waitcnt lgkmcnt(12)
    v_mfma_f32_16x16x32_bf16 v[84:87], v[220:223], v[110:113], v[84:87]
    v_mfma_f32_16x16x32_bf16 v[88:91], v[220:223], v[114:117], v[88:91]
    v_mfma_f32_16x16x32_bf16 v[92:95], v[220:223], v[118:121], v[92:95]
    ds_read_b64_tr_b16 v[216:217], v234 offset:8192
    ds_read_b64_tr_b16 v[218:219], v234 offset:12288
    s_waitcnt lgkmcnt(12)
    v_mfma_f32_16x16x32_bf16 v[0:3], v[192:195], v[122:125], v[0:3]
    v_mfma_f32_16x16x32_bf16 v[4:7], v[192:195], v[126:129], v[4:7]
    v_mfma_f32_16x16x32_bf16 v[8:11], v[192:195], v[130:133], v[8:11]
    ds_read_b64_tr_b16 v[220:221], v235 offset:8192
    ds_read_b64_tr_b16 v[222:223], v235 offset:12288
    s_waitcnt lgkmcnt(12)
    v_mfma_f32_16x16x32_bf16 v[12:15], v[196:199], v[122:125], v[12:15]
    v_mfma_f32_16x16x32_bf16 v[16:19], v[196:199], v[126:129], v[16:19]
    v_mfma_f32_16x16x32_bf16 v[20:23], v[196:199], v[130:133], v[20:23]
    s_waitcnt lgkmcnt(10)
    v_mfma_f32_16x16x32_bf16 v[24:27], v[200:203], v[122:125], v[24:27]
    v_mfma_f32_16x16x32_bf16 v[28:31], v[200:203], v[126:129], v[28:31]
    v_mfma_f32_16x16x32_bf16 v[32:35], v[200:203], v[130:133], v[32:35]
    s_waitcnt lgkmcnt(8)
    v_mfma_f32_16x16x32_bf16 v[36:39], v[204:207], v[122:125], v[36:39]
    v_mfma_f32_16x16x32_bf16 v[40:43], v[204:207], v[126:129], v[40:43]
    v_mfma_f32_16x16x32_bf16 v[44:47], v[204:207], v[130:133], v[44:47]
    s_waitcnt lgkmcnt(6)
    v_mfma_f32_16x16x32_bf16 v[48:51], v[208:211], v[122:125], v[48:51]
    v_mfma_f32_16x16x32_bf16 v[52:55], v[208:211], v[126:129], v[52:55]
    v_mfma_f32_16x16x32_bf16 v[56:59], v[208:211], v[130:133], v[56:59]
    s_waitcnt lgkmcnt(4)
    v_mfma_f32_16x16x32_bf16 v[60:63], v[212:215], v[122:125], v[60:63]
    v_mfma_f32_16x16x32_bf16 v[64:67], v[212:215], v[126:129], v[64:67]
    v_mfma_f32_16x16x32_bf16 v[68:71], v[212:215], v[130:133], v[68:71]
    s_waitcnt lgkmcnt(2)
    v_mfma_f32_16x16x32_bf16 v[72:75], v[216:219], v[122:125], v[72:75]
    v_mfma_f32_16x16x32_bf16 v[76:79], v[216:219], v[126:129], v[76:79]
    v_mfma_f32_16x16x32_bf16 v[80:83], v[216:219], v[130:133], v[80:83]
    s_waitcnt lgkmcnt(0)
    v_mfma_f32_16x16x32_bf16 v[84:87], v[220:223], v[122:125], v[84:87]
    v_mfma_f32_16x16x32_bf16 v[88:91], v[220:223], v[126:129], v[88:91]
    v_mfma_f32_16x16x32_bf16 v[92:95], v[220:223], v[130:133], v[92:95]
    s_waitcnt vmcnt(20)
    s_barrier
    ds_read_b128 v[110:113], v253 offset:57344
    ds_read_b128 v[122:125], v253 offset:58368
    ds_read_b128 v[114:117], v253 offset:59392
    ds_read_b128 v[126:129], v253 offset:60416
    ds_read_b128 v[118:121], v253 offset:61440
    ds_read_b128 v[130:133], v253 offset:62464
    s_add_u32 s57, s58, 8
    s_and_b32 s57, s57, 15
    s_lshl_b32 s59, s57, 11
    s_lshl_b32 s57, s57, 16
    s_add_u32 m0, s29, 0
    s_add_u32 s32, s57, 0
    buffer_load_dwordx4 v236, s[8:11], s32 offen offset:0 lds
    s_add_u32 s32, s57, 3072
    buffer_load_dwordx4 v237, s[8:11], s32 offen offset:1024 lds
    s_add_u32 s32, s57, 6144
    buffer_load_dwordx4 v236, s[8:11], s32 offen offset:2048 lds
    s_add_u32 s32, s57, 9216
    buffer_load_dwordx4 v237, s[8:11], s32 offen offset:3072 lds
    s_add_u32 m0, s33, 16384
    s_add_u32 s32, s59, 0
    buffer_load_dwordx4 v252, s[12:15], s32 offen lds
    buffer_load_dwordx4 v252, s[12:15], s32 offen offset:1024 lds
    s_add_u32 m0, s33, 18432
    s_add_u32 s32, s59, 131072
    buffer_load_dwordx4 v252, s[12:15], s32 offen lds
    buffer_load_dwordx4 v252, s[12:15], s32 offen offset:1024 lds
    s_add_u32 m0, s33, 20480
    s_add_u32 s32, s59, 262144
    buffer_load_dwordx4 v252, s[12:15], s32 offen lds
    buffer_load_dwordx4 v252, s[12:15], s32 offen offset:1024 lds
    s_waitcnt lgkmcnt(0)
    ds_read_b64_tr_b16 v[192:193], v228 offset:40960
    ds_read_b64_tr_b16 v[194:195], v228 offset:45056
    ds_read_b64_tr_b16 v[196:197], v229 offset:40960
    ds_read_b64_tr_b16 v[198:199], v229 offset:45056
    ds_read_b64_tr_b16 v[200:201], v230 offset:40960
    ds_read_b64_tr_b16 v[202:203], v230 offset:45056
    ds_read_b64_tr_b16 v[204:205], v231 offset:40960
    ds_read_b64_tr_b16 v[206:207], v231 offset:45056
    ds_read_b64_tr_b16 v[208:209], v232 offset:40960
    ds_read_b64_tr_b16 v[210:211], v232 offset:45056
    ds_read_b64_tr_b16 v[212:213], v233 offset:40960
    ds_read_b64_tr_b16 v[214:215], v233 offset:45056
    ds_read_b64_tr_b16 v[216:217], v234 offset:40960
    ds_read_b64_tr_b16 v[218:219], v234 offset:45056
    s_waitcnt lgkmcnt(12)
    v_mfma_f32_16x16x32_bf16 v[0:3], v[192:195], v[110:113], v[0:3]
    v_mfma_f32_16x16x32_bf16 v[4:7], v[192:195], v[114:117], v[4:7]
    v_mfma_f32_16x16x32_bf16 v[8:11], v[192:195], v[118:121], v[8:11]
    ds_read_b64_tr_b16 v[220:221], v235 offset:40960
    ds_read_b64_tr_b16 v[222:223], v235 offset:45056
    s_waitcnt lgkmcnt(12)
    v_mfma_f32_16x16x32_bf16 v[12:15], v[196:199], v[110:113], v[12:15]
    v_mfma_f32_16x16x32_bf16 v[16:19], v[196:199], v[114:117], v[16:19]
    v_mfma_f32_16x16x32_bf16 v[20:23], v[196:199], v[118:121], v[20:23]
    ds_read_b64_tr_b16 v[192:193], v228 offset:49152
    ds_read_b64_tr_b16 v[194:195], v228 offset:53248
    s_waitcnt lgkmcnt(12)
    v_mfma_f32_16x16x32_bf16 v[24:27], v[200:203], v[110:113], v[24:27]
    v_mfma_f32_16x16x32_bf16 v[28:31], v[200:203], v[114:117], v[28:31]
    v_mfma_f32_16x16x32_bf16 v[32:35], v[200:203], v[118:121], v[32:35]
    ds_read_b64_tr_b16 v[196:197], v229 offset:49152
    ds_read_b64_tr_b16 v[198:199], v229 offset:53248
    s_waitcnt lgkmcnt(12)
    v_mfma_f32_16x16x32_bf16 v[36:39], v[204:207], v[110:113], v[36:39]
    v_mfma_f32_16x16x32_bf16 v[40:43], v[204:207], v[114:117], v[40:43]
    v_mfma_f32_16x16x32_bf16 v[44:47], v[204:207], v[118:121], v[44:47]
    ds_read_b64_tr_b16 v[200:201], v230 offset:49152
    ds_read_b64_tr_b16 v[202:203], v230 offset:53248
    s_waitcnt lgkmcnt(12)
    v_mfma_f32_16x16x32_bf16 v[48:51], v[208:211], v[110:113], v[48:51]
    v_mfma_f32_16x16x32_bf16 v[52:55], v[208:211], v[114:117], v[52:55]
    v_mfma_f32_16x16x32_bf16 v[56:59], v[208:211], v[118:121], v[56:59]
    ds_read_b64_tr_b16 v[204:205], v231 offset:49152
    ds_read_b64_tr_b16 v[206:207], v231 offset:53248
    s_waitcnt lgkmcnt(12)
    v_mfma_f32_16x16x32_bf16 v[60:63], v[212:215], v[110:113], v[60:63]
    v_mfma_f32_16x16x32_bf16 v[64:67], v[212:215], v[114:117], v[64:67]
    v_mfma_f32_16x16x32_bf16 v[68:71], v[212:215], v[118:121], v[68:71]
    ds_read_b64_tr_b16 v[208:209], v232 offset:49152
    ds_read_b64_tr_b16 v[210:211], v232 offset:53248
    s_waitcnt lgkmcnt(12)
    v_mfma_f32_16x16x32_bf16 v[72:75], v[216:219], v[110:113], v[72:75]
    v_mfma_f32_16x16x32_bf16 v[76:79], v[216:219], v[114:117], v[76:79]
    v_mfma_f32_16x16x32_bf16 v[80:83], v[216:219], v[118:121], v[80:83]
    ds_read_b64_tr_b16 v[212:213], v233 offset:49152
    ds_read_b64_tr_b16 v[214:215], v233 offset:53248
    s_waitcnt lgkmcnt(12)
    v_mfma_f32_16x16x32_bf16 v[84:87], v[220:223], v[110:113], v[84:87]
    v_mfma_f32_16x16x32_bf16 v[88:91], v[220:223], v[114:117], v[88:91]
    v_mfma_f32_16x16x32_bf16 v[92:95], v[220:223], v[118:121], v[92:95]
    ds_read_b64_tr_b16 v[216:217], v234 offset:49152
    ds_read_b64_tr_b16 v[218:219], v234 offset:53248
    s_waitcnt lgkmcnt(12)
    v_mfma_f32_16x16x32_bf16 v[0:3], v[192:195], v[122:125], v[0:3]
    v_mfma_f32_16x16x32_bf16 v[4:7], v[192:195], v[126:129], v[4:7]
    v_mfma_f32_16x16x32_bf16 v[8:11], v[192:195], v[130:133], v[8:11]
    ds_read_b64_tr_b16 v[220:221], v235 offset:49152
    ds_read_b64_tr_b16 v[222:223], v235 offset:53248
    s_waitcnt lgkmcnt(12)
    v_mfma_f32_16x16x32_bf16 v[12:15], v[196:199], v[122:125], v[12:15]
    v_mfma_f32_16x16x32_bf16 v[16:19], v[196:199], v[126:129], v[16:19]
    v_mfma_f32_16x16x32_bf16 v[20:23], v[196:199], v[130:133], v[20:23]
    s_waitcnt lgkmcnt(10)
    v_mfma_f32_16x16x32_bf16 v[24:27], v[200:203], v[122:125], v[24:27]
    v_mfma_f32_16x16x32_bf16 v[28:31], v[200:203], v[126:129], v[28:31]
    v_mfma_f32_16x16x32_bf16 v[32:35], v[200:203], v[130:133], v[32:35]
    s_waitcnt lgkmcnt(8)
    v_mfma_f32_16x16x32_bf16 v[36:39], v[204:207], v[122:125], v[36:39]
    v_mfma_f32_16x16x32_bf16 v[40:43], v[204:207], v[126:129], v[40:43]
    v_mfma_f32_16x16x32_bf16 v[44:47], v[204:207], v[130:133], v[44:47]
    s_waitcnt lgkmcnt(6)
    v_mfma_f32_16x16x32_bf16 v[48:51], v[208:211], v[122:125], v[48:51]
    v_mfma_f32_16x16x32_bf16 v[52:55], v[208:211], v[126:129], v[52:55]
    v_mfma_f32_16x16x32_bf16 v[56:59], v[208:211], v[130:133], v[56:59]
    s_waitcnt lgkmcnt(4)
    v_mfma_f32_16x16x32_bf16 v[60:63], v[212:215], v[122:125], v[60:63]
    v_mfma_f32_16x16x32_bf16 v[64:67], v[212:215], v[126:129], v[64:67]
    v_mfma_f32_16x16x32_bf16 v[68:71], v[212:215], v[130:133], v[68:71]
    s_waitcnt lgkmcnt(2)
    v_mfma_f32_16x16x32_bf16 v[72:75], v[216:219], v[122:125], v[72:75]
    v_mfma_f32_16x16x32_bf16 v[76:79], v[216:219], v[126:129], v[76:79]
    v_mfma_f32_16x16x32_bf16 v[80:83], v[216:219], v[130:133], v[80:83]
    s_waitcnt lgkmcnt(0)
    v_mfma_f32_16x16x32_bf16 v[84:87], v[220:223], v[122:125], v[84:87]
    v_mfma_f32_16x16x32_bf16 v[88:91], v[220:223], v[126:129], v[88:91]
    v_mfma_f32_16x16x32_bf16 v[92:95], v[220:223], v[130:133], v[92:95]
    s_waitcnt vmcnt(20)
    s_barrier
    ds_read_b128 v[110:113], v254 offset:16384
    ds_read_b128 v[122:125], v254 offset:17408
    ds_read_b128 v[114:117], v254 offset:18432
    ds_read_b128 v[126:129], v254 offset:19456
    ds_read_b128 v[118:121], v254 offset:20480
    ds_read_b128 v[130:133], v254 offset:21504
    s_add_u32 s57, s58, 9
    s_and_b32 s57, s57, 15
    s_lshl_b32 s59, s57, 11
    s_lshl_b32 s57, s57, 16
    s_add_u32 m0, s29, 40960
    s_add_u32 s32, s57, 0
    buffer_load_dwordx4 v236, s[8:11], s32 offen offset:0 lds
    s_add_u32 s32, s57, 3072
    buffer_load_dwordx4 v237, s[8:11], s32 offen offset:1024 lds
    s_add_u32 s32, s57, 6144
    buffer_load_dwordx4 v236, s[8:11], s32 offen offset:2048 lds
    s_add_u32 s32, s57, 9216
    buffer_load_dwordx4 v237, s[8:11], s32 offen offset:3072 lds
    s_add_u32 m0, s33, 57344
    s_add_u32 s32, s59, 0
    buffer_load_dwordx4 v252, s[12:15], s32 offen lds
    buffer_load_dwordx4 v252, s[12:15], s32 offen offset:1024 lds
    s_add_u32 m0, s33, 59392
    s_add_u32 s32, s59, 131072
    buffer_load_dwordx4 v252, s[12:15], s32 offen lds
    buffer_load_dwordx4 v252, s[12:15], s32 offen offset:1024 lds
    s_add_u32 m0, s33, 61440
    s_add_u32 s32, s59, 262144
    buffer_load_dwordx4 v252, s[12:15], s32 offen lds
    buffer_load_dwordx4 v252, s[12:15], s32 offen offset:1024 lds
    s_waitcnt lgkmcnt(0)
    ds_read_b64_tr_b16 v[192:193], v100 offset:0
    ds_read_b64_tr_b16 v[194:195], v100 offset:4096
    ds_read_b64_tr_b16 v[196:197], v101 offset:0
    ds_read_b64_tr_b16 v[198:199], v101 offset:4096
    ds_read_b64_tr_b16 v[200:201], v102 offset:0
    ds_read_b64_tr_b16 v[202:203], v102 offset:4096
    ds_read_b64_tr_b16 v[204:205], v103 offset:0
    ds_read_b64_tr_b16 v[206:207], v103 offset:4096
    ds_read_b64_tr_b16 v[208:209], v104 offset:0
    ds_read_b64_tr_b16 v[210:211], v104 offset:4096
    ds_read_b64_tr_b16 v[212:213], v105 offset:0
    ds_read_b64_tr_b16 v[214:215], v105 offset:4096
    ds_read_b64_tr_b16 v[216:217], v106 offset:0
    ds_read_b64_tr_b16 v[218:219], v106 offset:4096
    s_waitcnt lgkmcnt(12)
    v_mfma_f32_16x16x32_bf16 v[0:3], v[192:195], v[110:113], v[0:3]
    v_mfma_f32_16x16x32_bf16 v[4:7], v[192:195], v[114:117], v[4:7]
    v_mfma_f32_16x16x32_bf16 v[8:11], v[192:195], v[118:121], v[8:11]
    ds_read_b64_tr_b16 v[220:221], v107 offset:0
    ds_read_b64_tr_b16 v[222:223], v107 offset:4096
    s_waitcnt lgkmcnt(12)
    v_mfma_f32_16x16x32_bf16 v[12:15], v[196:199], v[110:113], v[12:15]
    v_mfma_f32_16x16x32_bf16 v[16:19], v[196:199], v[114:117], v[16:19]
    v_mfma_f32_16x16x32_bf16 v[20:23], v[196:199], v[118:121], v[20:23]
    ds_read_b64_tr_b16 v[192:193], v100 offset:8192
    ds_read_b64_tr_b16 v[194:195], v100 offset:12288
    s_waitcnt lgkmcnt(12)
    v_mfma_f32_16x16x32_bf16 v[24:27], v[200:203], v[110:113], v[24:27]
    v_mfma_f32_16x16x32_bf16 v[28:31], v[200:203], v[114:117], v[28:31]
    v_mfma_f32_16x16x32_bf16 v[32:35], v[200:203], v[118:121], v[32:35]
    ds_read_b64_tr_b16 v[196:197], v101 offset:8192
    ds_read_b64_tr_b16 v[198:199], v101 offset:12288
    s_waitcnt lgkmcnt(12)
    v_mfma_f32_16x16x32_bf16 v[36:39], v[204:207], v[110:113], v[36:39]
    v_mfma_f32_16x16x32_bf16 v[40:43], v[204:207], v[114:117], v[40:43]
    v_mfma_f32_16x16x32_bf16 v[44:47], v[204:207], v[118:121], v[44:47]
    ds_read_b64_tr_b16 v[200:201], v102 offset:8192
    ds_read_b64_tr_b16 v[202:203], v102 offset:12288
    s_waitcnt lgkmcnt(12)
    v_mfma_f32_16x16x32_bf16 v[48:51], v[208:211], v[110:113], v[48:51]
    v_mfma_f32_16x16x32_bf16 v[52:55], v[208:211], v[114:117], v[52:55]
    v_mfma_f32_16x16x32_bf16 v[56:59], v[208:211], v[118:121], v[56:59]
    ds_read_b64_tr_b16 v[204:205], v103 offset:8192
    ds_read_b64_tr_b16 v[206:207], v103 offset:12288
    s_waitcnt lgkmcnt(12)
    v_mfma_f32_16x16x32_bf16 v[60:63], v[212:215], v[110:113], v[60:63]
    v_mfma_f32_16x16x32_bf16 v[64:67], v[212:215], v[114:117], v[64:67]
    v_mfma_f32_16x16x32_bf16 v[68:71], v[212:215], v[118:121], v[68:71]
    ds_read_b64_tr_b16 v[208:209], v104 offset:8192
    ds_read_b64_tr_b16 v[210:211], v104 offset:12288
    s_waitcnt lgkmcnt(12)
    v_mfma_f32_16x16x32_bf16 v[72:75], v[216:219], v[110:113], v[72:75]
    v_mfma_f32_16x16x32_bf16 v[76:79], v[216:219], v[114:117], v[76:79]
    v_mfma_f32_16x16x32_bf16 v[80:83], v[216:219], v[118:121], v[80:83]
    ds_read_b64_tr_b16 v[212:213], v105 offset:8192
    ds_read_b64_tr_b16 v[214:215], v105 offset:12288
    s_waitcnt lgkmcnt(12)
    v_mfma_f32_16x16x32_bf16 v[84:87], v[220:223], v[110:113], v[84:87]
    v_mfma_f32_16x16x32_bf16 v[88:91], v[220:223], v[114:117], v[88:91]
    v_mfma_f32_16x16x32_bf16 v[92:95], v[220:223], v[118:121], v[92:95]
    ds_read_b64_tr_b16 v[216:217], v106 offset:8192
    ds_read_b64_tr_b16 v[218:219], v106 offset:12288
    s_waitcnt lgkmcnt(12)
    v_mfma_f32_16x16x32_bf16 v[0:3], v[192:195], v[122:125], v[0:3]
    v_mfma_f32_16x16x32_bf16 v[4:7], v[192:195], v[126:129], v[4:7]
    v_mfma_f32_16x16x32_bf16 v[8:11], v[192:195], v[130:133], v[8:11]
    ds_read_b64_tr_b16 v[220:221], v107 offset:8192
    ds_read_b64_tr_b16 v[222:223], v107 offset:12288
    s_waitcnt lgkmcnt(12)
    v_mfma_f32_16x16x32_bf16 v[12:15], v[196:199], v[122:125], v[12:15]
    v_mfma_f32_16x16x32_bf16 v[16:19], v[196:199], v[126:129], v[16:19]
    v_mfma_f32_16x16x32_bf16 v[20:23], v[196:199], v[130:133], v[20:23]
    s_waitcnt lgkmcnt(10)
    v_mfma_f32_16x16x32_bf16 v[24:27], v[200:203], v[122:125], v[24:27]
    v_mfma_f32_16x16x32_bf16 v[28:31], v[200:203], v[126:129], v[28:31]
    v_mfma_f32_16x16x32_bf16 v[32:35], v[200:203], v[130:133], v[32:35]
    s_waitcnt lgkmcnt(8)
    v_mfma_f32_16x16x32_bf16 v[36:39], v[204:207], v[122:125], v[36:39]
    v_mfma_f32_16x16x32_bf16 v[40:43], v[204:207], v[126:129], v[40:43]
    v_mfma_f32_16x16x32_bf16 v[44:47], v[204:207], v[130:133], v[44:47]
    s_waitcnt lgkmcnt(6)
    v_mfma_f32_16x16x32_bf16 v[48:51], v[208:211], v[122:125], v[48:51]
    v_mfma_f32_16x16x32_bf16 v[52:55], v[208:211], v[126:129], v[52:55]
    v_mfma_f32_16x16x32_bf16 v[56:59], v[208:211], v[130:133], v[56:59]
    s_waitcnt lgkmcnt(4)
    v_mfma_f32_16x16x32_bf16 v[60:63], v[212:215], v[122:125], v[60:63]
    v_mfma_f32_16x16x32_bf16 v[64:67], v[212:215], v[126:129], v[64:67]
    v_mfma_f32_16x16x32_bf16 v[68:71], v[212:215], v[130:133], v[68:71]
    s_waitcnt lgkmcnt(2)
    v_mfma_f32_16x16x32_bf16 v[72:75], v[216:219], v[122:125], v[72:75]
    v_mfma_f32_16x16x32_bf16 v[76:79], v[216:219], v[126:129], v[76:79]
    v_mfma_f32_16x16x32_bf16 v[80:83], v[216:219], v[130:133], v[80:83]
    s_waitcnt lgkmcnt(0)
    v_mfma_f32_16x16x32_bf16 v[84:87], v[220:223], v[122:125], v[84:87]
    v_mfma_f32_16x16x32_bf16 v[88:91], v[220:223], v[126:129], v[88:91]
    v_mfma_f32_16x16x32_bf16 v[92:95], v[220:223], v[130:133], v[92:95]
    s_waitcnt vmcnt(20)
    s_barrier
    ds_read_b128 v[110:113], v254 offset:57344
    ds_read_b128 v[122:125], v254 offset:58368
    ds_read_b128 v[114:117], v254 offset:59392
    ds_read_b128 v[126:129], v254 offset:60416
    ds_read_b128 v[118:121], v254 offset:61440
    ds_read_b128 v[130:133], v254 offset:62464
    s_add_u32 s57, s58, 10
    s_and_b32 s57, s57, 15
    s_lshl_b32 s59, s57, 11
    s_lshl_b32 s57, s57, 16
    s_add_u32 m0, s29, 81920
    s_add_u32 s32, s57, 0
    buffer_load_dwordx4 v236, s[8:11], s32 offen offset:0 lds
    s_add_u32 s32, s57, 3072
    buffer_load_dwordx4 v237, s[8:11], s32 offen offset:1024 lds
    s_add_u32 s32, s57, 6144
    buffer_load_dwordx4 v236, s[8:11], s32 offen offset:2048 lds
    s_add_u32 s32, s57, 9216
    buffer_load_dwordx4 v237, s[8:11], s32 offen offset:3072 lds
    s_add_u32 m0, s33, 98304
    s_add_u32 s32, s59, 0
    buffer_load_dwordx4 v252, s[12:15], s32 offen lds
    buffer_load_dwordx4 v252, s[12:15], s32 offen offset:1024 lds
    s_add_u32 m0, s33, 100352
    s_add_u32 s32, s59, 131072
    buffer_load_dwordx4 v252, s[12:15], s32 offen lds
    buffer_load_dwordx4 v252, s[12:15], s32 offen offset:1024 lds
    s_add_u32 m0, s33, 102400
    s_add_u32 s32, s59, 262144
    buffer_load_dwordx4 v252, s[12:15], s32 offen lds
    buffer_load_dwordx4 v252, s[12:15], s32 offen offset:1024 lds
    s_waitcnt lgkmcnt(0)
    ds_read_b64_tr_b16 v[192:193], v100 offset:40960
    ds_read_b64_tr_b16 v[194:195], v100 offset:45056
    ds_read_b64_tr_b16 v[196:197], v101 offset:40960
    ds_read_b64_tr_b16 v[198:199], v101 offset:45056
    ds_read_b64_tr_b16 v[200:201], v102 offset:40960
    ds_read_b64_tr_b16 v[202:203], v102 offset:45056
    ds_read_b64_tr_b16 v[204:205], v103 offset:40960
    ds_read_b64_tr_b16 v[206:207], v103 offset:45056
    ds_read_b64_tr_b16 v[208:209], v104 offset:40960
    ds_read_b64_tr_b16 v[210:211], v104 offset:45056
    ds_read_b64_tr_b16 v[212:213], v105 offset:40960
    ds_read_b64_tr_b16 v[214:215], v105 offset:45056
    ds_read_b64_tr_b16 v[216:217], v106 offset:40960
    ds_read_b64_tr_b16 v[218:219], v106 offset:45056
    s_waitcnt lgkmcnt(12)
    v_mfma_f32_16x16x32_bf16 v[0:3], v[192:195], v[110:113], v[0:3]
    v_mfma_f32_16x16x32_bf16 v[4:7], v[192:195], v[114:117], v[4:7]
    v_mfma_f32_16x16x32_bf16 v[8:11], v[192:195], v[118:121], v[8:11]
    ds_read_b64_tr_b16 v[220:221], v107 offset:40960
    ds_read_b64_tr_b16 v[222:223], v107 offset:45056
    s_waitcnt lgkmcnt(12)
    v_mfma_f32_16x16x32_bf16 v[12:15], v[196:199], v[110:113], v[12:15]
    v_mfma_f32_16x16x32_bf16 v[16:19], v[196:199], v[114:117], v[16:19]
    v_mfma_f32_16x16x32_bf16 v[20:23], v[196:199], v[118:121], v[20:23]
    ds_read_b64_tr_b16 v[192:193], v100 offset:49152
    ds_read_b64_tr_b16 v[194:195], v100 offset:53248
    s_waitcnt lgkmcnt(12)
    v_mfma_f32_16x16x32_bf16 v[24:27], v[200:203], v[110:113], v[24:27]
    v_mfma_f32_16x16x32_bf16 v[28:31], v[200:203], v[114:117], v[28:31]
    v_mfma_f32_16x16x32_bf16 v[32:35], v[200:203], v[118:121], v[32:35]
    ds_read_b64_tr_b16 v[196:197], v101 offset:49152
    ds_read_b64_tr_b16 v[198:199], v101 offset:53248
    s_waitcnt lgkmcnt(12)
    v_mfma_f32_16x16x32_bf16 v[36:39], v[204:207], v[110:113], v[36:39]
    v_mfma_f32_16x16x32_bf16 v[40:43], v[204:207], v[114:117], v[40:43]
    v_mfma_f32_16x16x32_bf16 v[44:47], v[204:207], v[118:121], v[44:47]
    ds_read_b64_tr_b16 v[200:201], v102 offset:49152
    ds_read_b64_tr_b16 v[202:203], v102 offset:53248
    s_waitcnt lgkmcnt(12)
    v_mfma_f32_16x16x32_bf16 v[48:51], v[208:211], v[110:113], v[48:51]
    v_mfma_f32_16x16x32_bf16 v[52:55], v[208:211], v[114:117], v[52:55]
    v_mfma_f32_16x16x32_bf16 v[56:59], v[208:211], v[118:121], v[56:59]
    ds_read_b64_tr_b16 v[204:205], v103 offset:49152
    ds_read_b64_tr_b16 v[206:207], v103 offset:53248
    s_waitcnt lgkmcnt(12)
    v_mfma_f32_16x16x32_bf16 v[60:63], v[212:215], v[110:113], v[60:63]
    v_mfma_f32_16x16x32_bf16 v[64:67], v[212:215], v[114:117], v[64:67]
    v_mfma_f32_16x16x32_bf16 v[68:71], v[212:215], v[118:121], v[68:71]
    ds_read_b64_tr_b16 v[208:209], v104 offset:49152
    ds_read_b64_tr_b16 v[210:211], v104 offset:53248
    s_waitcnt lgkmcnt(12)
    v_mfma_f32_16x16x32_bf16 v[72:75], v[216:219], v[110:113], v[72:75]
    v_mfma_f32_16x16x32_bf16 v[76:79], v[216:219], v[114:117], v[76:79]
    v_mfma_f32_16x16x32_bf16 v[80:83], v[216:219], v[118:121], v[80:83]
    ds_read_b64_tr_b16 v[212:213], v105 offset:49152
    ds_read_b64_tr_b16 v[214:215], v105 offset:53248
    s_waitcnt lgkmcnt(12)
    v_mfma_f32_16x16x32_bf16 v[84:87], v[220:223], v[110:113], v[84:87]
    v_mfma_f32_16x16x32_bf16 v[88:91], v[220:223], v[114:117], v[88:91]
    v_mfma_f32_16x16x32_bf16 v[92:95], v[220:223], v[118:121], v[92:95]
    ds_read_b64_tr_b16 v[216:217], v106 offset:49152
    ds_read_b64_tr_b16 v[218:219], v106 offset:53248
    s_waitcnt lgkmcnt(12)
    v_mfma_f32_16x16x32_bf16 v[0:3], v[192:195], v[122:125], v[0:3]
    v_mfma_f32_16x16x32_bf16 v[4:7], v[192:195], v[126:129], v[4:7]
    v_mfma_f32_16x16x32_bf16 v[8:11], v[192:195], v[130:133], v[8:11]
    ds_read_b64_tr_b16 v[220:221], v107 offset:49152
    ds_read_b64_tr_b16 v[222:223], v107 offset:53248
    s_waitcnt lgkmcnt(12)
    v_mfma_f32_16x16x32_bf16 v[12:15], v[196:199], v[122:125], v[12:15]
    v_mfma_f32_16x16x32_bf16 v[16:19], v[196:199], v[126:129], v[16:19]
    v_mfma_f32_16x16x32_bf16 v[20:23], v[196:199], v[130:133], v[20:23]
    s_waitcnt lgkmcnt(10)
    v_mfma_f32_16x16x32_bf16 v[24:27], v[200:203], v[122:125], v[24:27]
    v_mfma_f32_16x16x32_bf16 v[28:31], v[200:203], v[126:129], v[28:31]
    v_mfma_f32_16x16x32_bf16 v[32:35], v[200:203], v[130:133], v[32:35]
    s_waitcnt lgkmcnt(8)
    v_mfma_f32_16x16x32_bf16 v[36:39], v[204:207], v[122:125], v[36:39]
    v_mfma_f32_16x16x32_bf16 v[40:43], v[204:207], v[126:129], v[40:43]
    v_mfma_f32_16x16x32_bf16 v[44:47], v[204:207], v[130:133], v[44:47]
    s_waitcnt lgkmcnt(6)
    v_mfma_f32_16x16x32_bf16 v[48:51], v[208:211], v[122:125], v[48:51]
    v_mfma_f32_16x16x32_bf16 v[52:55], v[208:211], v[126:129], v[52:55]
    v_mfma_f32_16x16x32_bf16 v[56:59], v[208:211], v[130:133], v[56:59]
    s_waitcnt lgkmcnt(4)
    v_mfma_f32_16x16x32_bf16 v[60:63], v[212:215], v[122:125], v[60:63]
    v_mfma_f32_16x16x32_bf16 v[64:67], v[212:215], v[126:129], v[64:67]
    v_mfma_f32_16x16x32_bf16 v[68:71], v[212:215], v[130:133], v[68:71]
    s_waitcnt lgkmcnt(2)
    v_mfma_f32_16x16x32_bf16 v[72:75], v[216:219], v[122:125], v[72:75]
    v_mfma_f32_16x16x32_bf16 v[76:79], v[216:219], v[126:129], v[76:79]
    v_mfma_f32_16x16x32_bf16 v[80:83], v[216:219], v[130:133], v[80:83]
    s_waitcnt lgkmcnt(0)
    v_mfma_f32_16x16x32_bf16 v[84:87], v[220:223], v[122:125], v[84:87]
    v_mfma_f32_16x16x32_bf16 v[88:91], v[220:223], v[126:129], v[88:91]
    v_mfma_f32_16x16x32_bf16 v[92:95], v[220:223], v[130:133], v[92:95]
    s_waitcnt vmcnt(20)
    s_barrier
    ds_read_b128 v[110:113], v253 offset:16384
    ds_read_b128 v[122:125], v253 offset:17408
    ds_read_b128 v[114:117], v253 offset:18432
    ds_read_b128 v[126:129], v253 offset:19456
    ds_read_b128 v[118:121], v253 offset:20480
    ds_read_b128 v[130:133], v253 offset:21504
    s_add_u32 s57, s58, 11
    s_and_b32 s57, s57, 15
    s_lshl_b32 s59, s57, 11
    s_lshl_b32 s57, s57, 16
    s_add_u32 m0, s29, 122880
    s_add_u32 s32, s57, 0
    buffer_load_dwordx4 v236, s[8:11], s32 offen offset:0 lds
    s_add_u32 s32, s57, 3072
    buffer_load_dwordx4 v237, s[8:11], s32 offen offset:1024 lds
    s_add_u32 s32, s57, 6144
    buffer_load_dwordx4 v236, s[8:11], s32 offen offset:2048 lds
    s_add_u32 s32, s57, 9216
    buffer_load_dwordx4 v237, s[8:11], s32 offen offset:3072 lds
    s_add_u32 m0, s33, 139264
    s_add_u32 s32, s59, 0
    buffer_load_dwordx4 v252, s[12:15], s32 offen lds
    buffer_load_dwordx4 v252, s[12:15], s32 offen offset:1024 lds
    s_add_u32 m0, s33, 141312
    s_add_u32 s32, s59, 131072
    buffer_load_dwordx4 v252, s[12:15], s32 offen lds
    buffer_load_dwordx4 v252, s[12:15], s32 offen offset:1024 lds
    s_add_u32 m0, s33, 143360
    s_add_u32 s32, s59, 262144
    buffer_load_dwordx4 v252, s[12:15], s32 offen lds
    buffer_load_dwordx4 v252, s[12:15], s32 offen offset:1024 lds
    s_waitcnt lgkmcnt(0)
    ds_read_b64_tr_b16 v[192:193], v228 offset:0
    ds_read_b64_tr_b16 v[194:195], v228 offset:4096
    ds_read_b64_tr_b16 v[196:197], v229 offset:0
    ds_read_b64_tr_b16 v[198:199], v229 offset:4096
    ds_read_b64_tr_b16 v[200:201], v230 offset:0
    ds_read_b64_tr_b16 v[202:203], v230 offset:4096
    ds_read_b64_tr_b16 v[204:205], v231 offset:0
    ds_read_b64_tr_b16 v[206:207], v231 offset:4096
    ds_read_b64_tr_b16 v[208:209], v232 offset:0
    ds_read_b64_tr_b16 v[210:211], v232 offset:4096
    ds_read_b64_tr_b16 v[212:213], v233 offset:0
    ds_read_b64_tr_b16 v[214:215], v233 offset:4096
    ds_read_b64_tr_b16 v[216:217], v234 offset:0
    ds_read_b64_tr_b16 v[218:219], v234 offset:4096
    s_waitcnt lgkmcnt(12)
    v_mfma_f32_16x16x32_bf16 v[0:3], v[192:195], v[110:113], v[0:3]
    v_mfma_f32_16x16x32_bf16 v[4:7], v[192:195], v[114:117], v[4:7]
    v_mfma_f32_16x16x32_bf16 v[8:11], v[192:195], v[118:121], v[8:11]
    ds_read_b64_tr_b16 v[220:221], v235 offset:0
    ds_read_b64_tr_b16 v[222:223], v235 offset:4096
    s_waitcnt lgkmcnt(12)
    v_mfma_f32_16x16x32_bf16 v[12:15], v[196:199], v[110:113], v[12:15]
    v_mfma_f32_16x16x32_bf16 v[16:19], v[196:199], v[114:117], v[16:19]
    v_mfma_f32_16x16x32_bf16 v[20:23], v[196:199], v[118:121], v[20:23]
    ds_read_b64_tr_b16 v[192:193], v228 offset:8192
    ds_read_b64_tr_b16 v[194:195], v228 offset:12288
    s_waitcnt lgkmcnt(12)
    v_mfma_f32_16x16x32_bf16 v[24:27], v[200:203], v[110:113], v[24:27]
    v_mfma_f32_16x16x32_bf16 v[28:31], v[200:203], v[114:117], v[28:31]
    v_mfma_f32_16x16x32_bf16 v[32:35], v[200:203], v[118:121], v[32:35]
    ds_read_b64_tr_b16 v[196:197], v229 offset:8192
    ds_read_b64_tr_b16 v[198:199], v229 offset:12288
    s_waitcnt lgkmcnt(12)
    v_mfma_f32_16x16x32_bf16 v[36:39], v[204:207], v[110:113], v[36:39]
    v_mfma_f32_16x16x32_bf16 v[40:43], v[204:207], v[114:117], v[40:43]
    v_mfma_f32_16x16x32_bf16 v[44:47], v[204:207], v[118:121], v[44:47]
    ds_read_b64_tr_b16 v[200:201], v230 offset:8192
    ds_read_b64_tr_b16 v[202:203], v230 offset:12288
    s_waitcnt lgkmcnt(12)
    v_mfma_f32_16x16x32_bf16 v[48:51], v[208:211], v[110:113], v[48:51]
    v_mfma_f32_16x16x32_bf16 v[52:55], v[208:211], v[114:117], v[52:55]
    v_mfma_f32_16x16x32_bf16 v[56:59], v[208:211], v[118:121], v[56:59]
    ds_read_b64_tr_b16 v[204:205], v231 offset:8192
    ds_read_b64_tr_b16 v[206:207], v231 offset:12288
    s_waitcnt lgkmcnt(12)
    v_mfma_f32_16x16x32_bf16 v[60:63], v[212:215], v[110:113], v[60:63]
    v_mfma_f32_16x16x32_bf16 v[64:67], v[212:215], v[114:117], v[64:67]
    v_mfma_f32_16x16x32_bf16 v[68:71], v[212:215], v[118:121], v[68:71]
    ds_read_b64_tr_b16 v[208:209], v232 offset:8192
    ds_read_b64_tr_b16 v[210:211], v232 offset:12288
    s_waitcnt lgkmcnt(12)
    v_mfma_f32_16x16x32_bf16 v[72:75], v[216:219], v[110:113], v[72:75]
    v_mfma_f32_16x16x32_bf16 v[76:79], v[216:219], v[114:117], v[76:79]
    v_mfma_f32_16x16x32_bf16 v[80:83], v[216:219], v[118:121], v[80:83]
    ds_read_b64_tr_b16 v[212:213], v233 offset:8192
    ds_read_b64_tr_b16 v[214:215], v233 offset:12288
    s_waitcnt lgkmcnt(12)
    v_mfma_f32_16x16x32_bf16 v[84:87], v[220:223], v[110:113], v[84:87]
    v_mfma_f32_16x16x32_bf16 v[88:91], v[220:223], v[114:117], v[88:91]
    v_mfma_f32_16x16x32_bf16 v[92:95], v[220:223], v[118:121], v[92:95]
    ds_read_b64_tr_b16 v[216:217], v234 offset:8192
    ds_read_b64_tr_b16 v[218:219], v234 offset:12288
    s_waitcnt lgkmcnt(12)
    v_mfma_f32_16x16x32_bf16 v[0:3], v[192:195], v[122:125], v[0:3]
    v_mfma_f32_16x16x32_bf16 v[4:7], v[192:195], v[126:129], v[4:7]
    v_mfma_f32_16x16x32_bf16 v[8:11], v[192:195], v[130:133], v[8:11]
    ds_read_b64_tr_b16 v[220:221], v235 offset:8192
    ds_read_b64_tr_b16 v[222:223], v235 offset:12288
    s_waitcnt lgkmcnt(12)
    v_mfma_f32_16x16x32_bf16 v[12:15], v[196:199], v[122:125], v[12:15]
    v_mfma_f32_16x16x32_bf16 v[16:19], v[196:199], v[126:129], v[16:19]
    v_mfma_f32_16x16x32_bf16 v[20:23], v[196:199], v[130:133], v[20:23]
    s_waitcnt lgkmcnt(10)
    v_mfma_f32_16x16x32_bf16 v[24:27], v[200:203], v[122:125], v[24:27]
    v_mfma_f32_16x16x32_bf16 v[28:31], v[200:203], v[126:129], v[28:31]
    v_mfma_f32_16x16x32_bf16 v[32:35], v[200:203], v[130:133], v[32:35]
    s_waitcnt lgkmcnt(8)
    v_mfma_f32_16x16x32_bf16 v[36:39], v[204:207], v[122:125], v[36:39]
    v_mfma_f32_16x16x32_bf16 v[40:43], v[204:207], v[126:129], v[40:43]
    v_mfma_f32_16x16x32_bf16 v[44:47], v[204:207], v[130:133], v[44:47]
    s_waitcnt lgkmcnt(6)
    v_mfma_f32_16x16x32_bf16 v[48:51], v[208:211], v[122:125], v[48:51]
    v_mfma_f32_16x16x32_bf16 v[52:55], v[208:211], v[126:129], v[52:55]
    v_mfma_f32_16x16x32_bf16 v[56:59], v[208:211], v[130:133], v[56:59]
    s_waitcnt lgkmcnt(4)
    v_mfma_f32_16x16x32_bf16 v[60:63], v[212:215], v[122:125], v[60:63]
    v_mfma_f32_16x16x32_bf16 v[64:67], v[212:215], v[126:129], v[64:67]
    v_mfma_f32_16x16x32_bf16 v[68:71], v[212:215], v[130:133], v[68:71]
    s_waitcnt lgkmcnt(2)
    v_mfma_f32_16x16x32_bf16 v[72:75], v[216:219], v[122:125], v[72:75]
    v_mfma_f32_16x16x32_bf16 v[76:79], v[216:219], v[126:129], v[76:79]
    v_mfma_f32_16x16x32_bf16 v[80:83], v[216:219], v[130:133], v[80:83]
    s_waitcnt lgkmcnt(0)
    v_mfma_f32_16x16x32_bf16 v[84:87], v[220:223], v[122:125], v[84:87]
    v_mfma_f32_16x16x32_bf16 v[88:91], v[220:223], v[126:129], v[88:91]
    v_mfma_f32_16x16x32_bf16 v[92:95], v[220:223], v[130:133], v[92:95]
    s_waitcnt vmcnt(20)
    s_barrier
    ds_read_b128 v[110:113], v253 offset:57344
    ds_read_b128 v[122:125], v253 offset:58368
    ds_read_b128 v[114:117], v253 offset:59392
    ds_read_b128 v[126:129], v253 offset:60416
    ds_read_b128 v[118:121], v253 offset:61440
    ds_read_b128 v[130:133], v253 offset:62464
    s_add_u32 s57, s58, 12
    s_and_b32 s57, s57, 15
    s_lshl_b32 s59, s57, 11
    s_lshl_b32 s57, s57, 16
    s_add_u32 m0, s29, 0
    s_add_u32 s32, s57, 0
    buffer_load_dwordx4 v236, s[8:11], s32 offen offset:0 lds
    s_add_u32 s32, s57, 3072
    buffer_load_dwordx4 v237, s[8:11], s32 offen offset:1024 lds
    s_add_u32 s32, s57, 6144
    buffer_load_dwordx4 v236, s[8:11], s32 offen offset:2048 lds
    s_add_u32 s32, s57, 9216
    buffer_load_dwordx4 v237, s[8:11], s32 offen offset:3072 lds
    s_add_u32 m0, s33, 16384
    s_add_u32 s32, s59, 0
    buffer_load_dwordx4 v252, s[12:15], s32 offen lds
    buffer_load_dwordx4 v252, s[12:15], s32 offen offset:1024 lds
    s_add_u32 m0, s33, 18432
    s_add_u32 s32, s59, 131072
    buffer_load_dwordx4 v252, s[12:15], s32 offen lds
    buffer_load_dwordx4 v252, s[12:15], s32 offen offset:1024 lds
    s_add_u32 m0, s33, 20480
    s_add_u32 s32, s59, 262144
    buffer_load_dwordx4 v252, s[12:15], s32 offen lds
    buffer_load_dwordx4 v252, s[12:15], s32 offen offset:1024 lds
    s_waitcnt lgkmcnt(0)
    ds_read_b64_tr_b16 v[192:193], v228 offset:40960
    ds_read_b64_tr_b16 v[194:195], v228 offset:45056
    ds_read_b64_tr_b16 v[196:197], v229 offset:40960
    ds_read_b64_tr_b16 v[198:199], v229 offset:45056
    ds_read_b64_tr_b16 v[200:201], v230 offset:40960
    ds_read_b64_tr_b16 v[202:203], v230 offset:45056
    ds_read_b64_tr_b16 v[204:205], v231 offset:40960
    ds_read_b64_tr_b16 v[206:207], v231 offset:45056
    ds_read_b64_tr_b16 v[208:209], v232 offset:40960
    ds_read_b64_tr_b16 v[210:211], v232 offset:45056
    ds_read_b64_tr_b16 v[212:213], v233 offset:40960
    ds_read_b64_tr_b16 v[214:215], v233 offset:45056
    ds_read_b64_tr_b16 v[216:217], v234 offset:40960
    ds_read_b64_tr_b16 v[218:219], v234 offset:45056
    s_waitcnt lgkmcnt(12)
    v_mfma_f32_16x16x32_bf16 v[0:3], v[192:195], v[110:113], v[0:3]
    v_mfma_f32_16x16x32_bf16 v[4:7], v[192:195], v[114:117], v[4:7]
    v_mfma_f32_16x16x32_bf16 v[8:11], v[192:195], v[118:121], v[8:11]
    ds_read_b64_tr_b16 v[220:221], v235 offset:40960
    ds_read_b64_tr_b16 v[222:223], v235 offset:45056
    s_waitcnt lgkmcnt(12)
    v_mfma_f32_16x16x32_bf16 v[12:15], v[196:199], v[110:113], v[12:15]
    v_mfma_f32_16x16x32_bf16 v[16:19], v[196:199], v[114:117], v[16:19]
    v_mfma_f32_16x16x32_bf16 v[20:23], v[196:199], v[118:121], v[20:23]
    ds_read_b64_tr_b16 v[192:193], v228 offset:49152
    ds_read_b64_tr_b16 v[194:195], v228 offset:53248
    s_waitcnt lgkmcnt(12)
    v_mfma_f32_16x16x32_bf16 v[24:27], v[200:203], v[110:113], v[24:27]
    v_mfma_f32_16x16x32_bf16 v[28:31], v[200:203], v[114:117], v[28:31]
    v_mfma_f32_16x16x32_bf16 v[32:35], v[200:203], v[118:121], v[32:35]
    ds_read_b64_tr_b16 v[196:197], v229 offset:49152
    ds_read_b64_tr_b16 v[198:199], v229 offset:53248
    s_waitcnt lgkmcnt(12)
    v_mfma_f32_16x16x32_bf16 v[36:39], v[204:207], v[110:113], v[36:39]
    v_mfma_f32_16x16x32_bf16 v[40:43], v[204:207], v[114:117], v[40:43]
    v_mfma_f32_16x16x32_bf16 v[44:47], v[204:207], v[118:121], v[44:47]
    ds_read_b64_tr_b16 v[200:201], v230 offset:49152
    ds_read_b64_tr_b16 v[202:203], v230 offset:53248
    s_waitcnt lgkmcnt(12)
    v_mfma_f32_16x16x32_bf16 v[48:51], v[208:211], v[110:113], v[48:51]
    v_mfma_f32_16x16x32_bf16 v[52:55], v[208:211], v[114:117], v[52:55]
    v_mfma_f32_16x16x32_bf16 v[56:59], v[208:211], v[118:121], v[56:59]
    ds_read_b64_tr_b16 v[204:205], v231 offset:49152
    ds_read_b64_tr_b16 v[206:207], v231 offset:53248
    s_waitcnt lgkmcnt(12)
    v_mfma_f32_16x16x32_bf16 v[60:63], v[212:215], v[110:113], v[60:63]
    v_mfma_f32_16x16x32_bf16 v[64:67], v[212:215], v[114:117], v[64:67]
    v_mfma_f32_16x16x32_bf16 v[68:71], v[212:215], v[118:121], v[68:71]
    ds_read_b64_tr_b16 v[208:209], v232 offset:49152
    ds_read_b64_tr_b16 v[210:211], v232 offset:53248
    s_waitcnt lgkmcnt(12)
    v_mfma_f32_16x16x32_bf16 v[72:75], v[216:219], v[110:113], v[72:75]
    v_mfma_f32_16x16x32_bf16 v[76:79], v[216:219], v[114:117], v[76:79]
    v_mfma_f32_16x16x32_bf16 v[80:83], v[216:219], v[118:121], v[80:83]
    ds_read_b64_tr_b16 v[212:213], v233 offset:49152
    ds_read_b64_tr_b16 v[214:215], v233 offset:53248
    s_waitcnt lgkmcnt(12)
    v_mfma_f32_16x16x32_bf16 v[84:87], v[220:223], v[110:113], v[84:87]
    v_mfma_f32_16x16x32_bf16 v[88:91], v[220:223], v[114:117], v[88:91]
    v_mfma_f32_16x16x32_bf16 v[92:95], v[220:223], v[118:121], v[92:95]
    ds_read_b64_tr_b16 v[216:217], v234 offset:49152
    ds_read_b64_tr_b16 v[218:219], v234 offset:53248
    s_waitcnt lgkmcnt(12)
    v_mfma_f32_16x16x32_bf16 v[0:3], v[192:195], v[122:125], v[0:3]
    v_mfma_f32_16x16x32_bf16 v[4:7], v[192:195], v[126:129], v[4:7]
    v_mfma_f32_16x16x32_bf16 v[8:11], v[192:195], v[130:133], v[8:11]
    ds_read_b64_tr_b16 v[220:221], v235 offset:49152
    ds_read_b64_tr_b16 v[222:223], v235 offset:53248
    s_waitcnt lgkmcnt(12)
    v_mfma_f32_16x16x32_bf16 v[12:15], v[196:199], v[122:125], v[12:15]
    v_mfma_f32_16x16x32_bf16 v[16:19], v[196:199], v[126:129], v[16:19]
    v_mfma_f32_16x16x32_bf16 v[20:23], v[196:199], v[130:133], v[20:23]
    s_waitcnt lgkmcnt(10)
    v_mfma_f32_16x16x32_bf16 v[24:27], v[200:203], v[122:125], v[24:27]
    v_mfma_f32_16x16x32_bf16 v[28:31], v[200:203], v[126:129], v[28:31]
    v_mfma_f32_16x16x32_bf16 v[32:35], v[200:203], v[130:133], v[32:35]
    s_waitcnt lgkmcnt(8)
    v_mfma_f32_16x16x32_bf16 v[36:39], v[204:207], v[122:125], v[36:39]
    v_mfma_f32_16x16x32_bf16 v[40:43], v[204:207], v[126:129], v[40:43]
    v_mfma_f32_16x16x32_bf16 v[44:47], v[204:207], v[130:133], v[44:47]
    s_waitcnt lgkmcnt(6)
    v_mfma_f32_16x16x32_bf16 v[48:51], v[208:211], v[122:125], v[48:51]
    v_mfma_f32_16x16x32_bf16 v[52:55], v[208:211], v[126:129], v[52:55]
    v_mfma_f32_16x16x32_bf16 v[56:59], v[208:211], v[130:133], v[56:59]
    s_waitcnt lgkmcnt(4)
    v_mfma_f32_16x16x32_bf16 v[60:63], v[212:215], v[122:125], v[60:63]
    v_mfma_f32_16x16x32_bf16 v[64:67], v[212:215], v[126:129], v[64:67]
    v_mfma_f32_16x16x32_bf16 v[68:71], v[212:215], v[130:133], v[68:71]
    s_waitcnt lgkmcnt(2)
    v_mfma_f32_16x16x32_bf16 v[72:75], v[216:219], v[122:125], v[72:75]
    v_mfma_f32_16x16x32_bf16 v[76:79], v[216:219], v[126:129], v[76:79]
    v_mfma_f32_16x16x32_bf16 v[80:83], v[216:219], v[130:133], v[80:83]
    s_waitcnt lgkmcnt(0)
    v_mfma_f32_16x16x32_bf16 v[84:87], v[220:223], v[122:125], v[84:87]
    v_mfma_f32_16x16x32_bf16 v[88:91], v[220:223], v[126:129], v[88:91]
    v_mfma_f32_16x16x32_bf16 v[92:95], v[220:223], v[130:133], v[92:95]
    s_waitcnt vmcnt(20)
    s_barrier
    ds_read_b128 v[110:113], v254 offset:16384
    ds_read_b128 v[122:125], v254 offset:17408
    ds_read_b128 v[114:117], v254 offset:18432
    ds_read_b128 v[126:129], v254 offset:19456
    ds_read_b128 v[118:121], v254 offset:20480
    ds_read_b128 v[130:133], v254 offset:21504
    s_add_u32 s57, s58, 13
    s_and_b32 s57, s57, 15
    s_lshl_b32 s59, s57, 11
    s_lshl_b32 s57, s57, 16
    s_add_u32 m0, s29, 40960
    s_add_u32 s32, s57, 0
    buffer_load_dwordx4 v236, s[8:11], s32 offen offset:0 lds
    s_add_u32 s32, s57, 3072
    buffer_load_dwordx4 v237, s[8:11], s32 offen offset:1024 lds
    s_add_u32 s32, s57, 6144
    buffer_load_dwordx4 v236, s[8:11], s32 offen offset:2048 lds
    s_add_u32 s32, s57, 9216
    buffer_load_dwordx4 v237, s[8:11], s32 offen offset:3072 lds
    s_add_u32 m0, s33, 57344
    s_add_u32 s32, s59, 0
    buffer_load_dwordx4 v252, s[12:15], s32 offen lds
    buffer_load_dwordx4 v252, s[12:15], s32 offen offset:1024 lds
    s_add_u32 m0, s33, 59392
    s_add_u32 s32, s59, 131072
    buffer_load_dwordx4 v252, s[12:15], s32 offen lds
    buffer_load_dwordx4 v252, s[12:15], s32 offen offset:1024 lds
    s_add_u32 m0, s33, 61440
    s_add_u32 s32, s59, 262144
    buffer_load_dwordx4 v252, s[12:15], s32 offen lds
    buffer_load_dwordx4 v252, s[12:15], s32 offen offset:1024 lds
    s_waitcnt lgkmcnt(0)
    ds_read_b64_tr_b16 v[192:193], v100 offset:0
    ds_read_b64_tr_b16 v[194:195], v100 offset:4096
    ds_read_b64_tr_b16 v[196:197], v101 offset:0
    ds_read_b64_tr_b16 v[198:199], v101 offset:4096
    ds_read_b64_tr_b16 v[200:201], v102 offset:0
    ds_read_b64_tr_b16 v[202:203], v102 offset:4096
    ds_read_b64_tr_b16 v[204:205], v103 offset:0
    ds_read_b64_tr_b16 v[206:207], v103 offset:4096
    ds_read_b64_tr_b16 v[208:209], v104 offset:0
    ds_read_b64_tr_b16 v[210:211], v104 offset:4096
    ds_read_b64_tr_b16 v[212:213], v105 offset:0
    ds_read_b64_tr_b16 v[214:215], v105 offset:4096
    ds_read_b64_tr_b16 v[216:217], v106 offset:0
    ds_read_b64_tr_b16 v[218:219], v106 offset:4096
    s_waitcnt lgkmcnt(12)
    v_mfma_f32_16x16x32_bf16 v[0:3], v[192:195], v[110:113], v[0:3]
    v_mfma_f32_16x16x32_bf16 v[4:7], v[192:195], v[114:117], v[4:7]
    v_mfma_f32_16x16x32_bf16 v[8:11], v[192:195], v[118:121], v[8:11]
    ds_read_b64_tr_b16 v[220:221], v107 offset:0
    ds_read_b64_tr_b16 v[222:223], v107 offset:4096
    s_waitcnt lgkmcnt(12)
    v_mfma_f32_16x16x32_bf16 v[12:15], v[196:199], v[110:113], v[12:15]
    v_mfma_f32_16x16x32_bf16 v[16:19], v[196:199], v[114:117], v[16:19]
    v_mfma_f32_16x16x32_bf16 v[20:23], v[196:199], v[118:121], v[20:23]
    ds_read_b64_tr_b16 v[192:193], v100 offset:8192
    ds_read_b64_tr_b16 v[194:195], v100 offset:12288
    s_waitcnt lgkmcnt(12)
    v_mfma_f32_16x16x32_bf16 v[24:27], v[200:203], v[110:113], v[24:27]
    v_mfma_f32_16x16x32_bf16 v[28:31], v[200:203], v[114:117], v[28:31]
    v_mfma_f32_16x16x32_bf16 v[32:35], v[200:203], v[118:121], v[32:35]
    ds_read_b64_tr_b16 v[196:197], v101 offset:8192
    ds_read_b64_tr_b16 v[198:199], v101 offset:12288
    s_waitcnt lgkmcnt(12)
    v_mfma_f32_16x16x32_bf16 v[36:39], v[204:207], v[110:113], v[36:39]
    v_mfma_f32_16x16x32_bf16 v[40:43], v[204:207], v[114:117], v[40:43]
    v_mfma_f32_16x16x32_bf16 v[44:47], v[204:207], v[118:121], v[44:47]
    ds_read_b64_tr_b16 v[200:201], v102 offset:8192
    ds_read_b64_tr_b16 v[202:203], v102 offset:12288
    s_waitcnt lgkmcnt(12)
    v_mfma_f32_16x16x32_bf16 v[48:51], v[208:211], v[110:113], v[48:51]
    v_mfma_f32_16x16x32_bf16 v[52:55], v[208:211], v[114:117], v[52:55]
    v_mfma_f32_16x16x32_bf16 v[56:59], v[208:211], v[118:121], v[56:59]
    ds_read_b64_tr_b16 v[204:205], v103 offset:8192
    ds_read_b64_tr_b16 v[206:207], v103 offset:12288
    s_waitcnt lgkmcnt(12)
    v_mfma_f32_16x16x32_bf16 v[60:63], v[212:215], v[110:113], v[60:63]
    v_mfma_f32_16x16x32_bf16 v[64:67], v[212:215], v[114:117], v[64:67]
    v_mfma_f32_16x16x32_bf16 v[68:71], v[212:215], v[118:121], v[68:71]
    ds_read_b64_tr_b16 v[208:209], v104 offset:8192
    ds_read_b64_tr_b16 v[210:211], v104 offset:12288
    s_waitcnt lgkmcnt(12)
    v_mfma_f32_16x16x32_bf16 v[72:75], v[216:219], v[110:113], v[72:75]
    v_mfma_f32_16x16x32_bf16 v[76:79], v[216:219], v[114:117], v[76:79]
    v_mfma_f32_16x16x32_bf16 v[80:83], v[216:219], v[118:121], v[80:83]
    ds_read_b64_tr_b16 v[212:213], v105 offset:8192
    ds_read_b64_tr_b16 v[214:215], v105 offset:12288
    s_waitcnt lgkmcnt(12)
    v_mfma_f32_16x16x32_bf16 v[84:87], v[220:223], v[110:113], v[84:87]
    v_mfma_f32_16x16x32_bf16 v[88:91], v[220:223], v[114:117], v[88:91]
    v_mfma_f32_16x16x32_bf16 v[92:95], v[220:223], v[118:121], v[92:95]
    ds_read_b64_tr_b16 v[216:217], v106 offset:8192
    ds_read_b64_tr_b16 v[218:219], v106 offset:12288
    s_waitcnt lgkmcnt(12)
    v_mfma_f32_16x16x32_bf16 v[0:3], v[192:195], v[122:125], v[0:3]
    v_mfma_f32_16x16x32_bf16 v[4:7], v[192:195], v[126:129], v[4:7]
    v_mfma_f32_16x16x32_bf16 v[8:11], v[192:195], v[130:133], v[8:11]
    ds_read_b64_tr_b16 v[220:221], v107 offset:8192
    ds_read_b64_tr_b16 v[222:223], v107 offset:12288
    s_waitcnt lgkmcnt(12)
    v_mfma_f32_16x16x32_bf16 v[12:15], v[196:199], v[122:125], v[12:15]
    v_mfma_f32_16x16x32_bf16 v[16:19], v[196:199], v[126:129], v[16:19]
    v_mfma_f32_16x16x32_bf16 v[20:23], v[196:199], v[130:133], v[20:23]
    s_waitcnt lgkmcnt(10)
    v_mfma_f32_16x16x32_bf16 v[24:27], v[200:203], v[122:125], v[24:27]
    v_mfma_f32_16x16x32_bf16 v[28:31], v[200:203], v[126:129], v[28:31]
    v_mfma_f32_16x16x32_bf16 v[32:35], v[200:203], v[130:133], v[32:35]
    s_waitcnt lgkmcnt(8)
    v_mfma_f32_16x16x32_bf16 v[36:39], v[204:207], v[122:125], v[36:39]
    v_mfma_f32_16x16x32_bf16 v[40:43], v[204:207], v[126:129], v[40:43]
    v_mfma_f32_16x16x32_bf16 v[44:47], v[204:207], v[130:133], v[44:47]
    s_waitcnt lgkmcnt(6)
    v_mfma_f32_16x16x32_bf16 v[48:51], v[208:211], v[122:125], v[48:51]
    v_mfma_f32_16x16x32_bf16 v[52:55], v[208:211], v[126:129], v[52:55]
    v_mfma_f32_16x16x32_bf16 v[56:59], v[208:211], v[130:133], v[56:59]
    s_waitcnt lgkmcnt(4)
    v_mfma_f32_16x16x32_bf16 v[60:63], v[212:215], v[122:125], v[60:63]
    v_mfma_f32_16x16x32_bf16 v[64:67], v[212:215], v[126:129], v[64:67]
    v_mfma_f32_16x16x32_bf16 v[68:71], v[212:215], v[130:133], v[68:71]
    s_waitcnt lgkmcnt(2)
    v_mfma_f32_16x16x32_bf16 v[72:75], v[216:219], v[122:125], v[72:75]
    v_mfma_f32_16x16x32_bf16 v[76:79], v[216:219], v[126:129], v[76:79]
    v_mfma_f32_16x16x32_bf16 v[80:83], v[216:219], v[130:133], v[80:83]
    s_waitcnt lgkmcnt(0)
    v_mfma_f32_16x16x32_bf16 v[84:87], v[220:223], v[122:125], v[84:87]
    v_mfma_f32_16x16x32_bf16 v[88:91], v[220:223], v[126:129], v[88:91]
    v_mfma_f32_16x16x32_bf16 v[92:95], v[220:223], v[130:133], v[92:95]
    s_waitcnt vmcnt(20)
    s_barrier
    ds_read_b128 v[110:113], v254 offset:57344
    ds_read_b128 v[122:125], v254 offset:58368
    ds_read_b128 v[114:117], v254 offset:59392
    ds_read_b128 v[126:129], v254 offset:60416
    ds_read_b128 v[118:121], v254 offset:61440
    ds_read_b128 v[130:133], v254 offset:62464
    s_add_u32 s57, s58, 14
    s_and_b32 s57, s57, 15
    s_lshl_b32 s59, s57, 11
    s_lshl_b32 s57, s57, 16
    s_add_u32 m0, s29, 81920
    s_add_u32 s32, s57, 0
    buffer_load_dwordx4 v236, s[8:11], s32 offen offset:0 lds
    s_add_u32 s32, s57, 3072
    buffer_load_dwordx4 v237, s[8:11], s32 offen offset:1024 lds
    s_add_u32 s32, s57, 6144
    buffer_load_dwordx4 v236, s[8:11], s32 offen offset:2048 lds
    s_add_u32 s32, s57, 9216
    buffer_load_dwordx4 v237, s[8:11], s32 offen offset:3072 lds
    s_add_u32 m0, s33, 98304
    s_add_u32 s32, s59, 0
    buffer_load_dwordx4 v252, s[12:15], s32 offen lds
    buffer_load_dwordx4 v252, s[12:15], s32 offen offset:1024 lds
    s_add_u32 m0, s33, 100352
    s_add_u32 s32, s59, 131072
    buffer_load_dwordx4 v252, s[12:15], s32 offen lds
    buffer_load_dwordx4 v252, s[12:15], s32 offen offset:1024 lds
    s_add_u32 m0, s33, 102400
    s_add_u32 s32, s59, 262144
    buffer_load_dwordx4 v252, s[12:15], s32 offen lds
    buffer_load_dwordx4 v252, s[12:15], s32 offen offset:1024 lds
    s_waitcnt lgkmcnt(0)
    ds_read_b64_tr_b16 v[192:193], v100 offset:40960
    ds_read_b64_tr_b16 v[194:195], v100 offset:45056
    ds_read_b64_tr_b16 v[196:197], v101 offset:40960
    ds_read_b64_tr_b16 v[198:199], v101 offset:45056
    ds_read_b64_tr_b16 v[200:201], v102 offset:40960
    ds_read_b64_tr_b16 v[202:203], v102 offset:45056
    ds_read_b64_tr_b16 v[204:205], v103 offset:40960
    ds_read_b64_tr_b16 v[206:207], v103 offset:45056
    ds_read_b64_tr_b16 v[208:209], v104 offset:40960
    ds_read_b64_tr_b16 v[210:211], v104 offset:45056
    ds_read_b64_tr_b16 v[212:213], v105 offset:40960
    ds_read_b64_tr_b16 v[214:215], v105 offset:45056
    ds_read_b64_tr_b16 v[216:217], v106 offset:40960
    ds_read_b64_tr_b16 v[218:219], v106 offset:45056
    s_waitcnt lgkmcnt(12)
    v_mfma_f32_16x16x32_bf16 v[0:3], v[192:195], v[110:113], v[0:3]
    v_mfma_f32_16x16x32_bf16 v[4:7], v[192:195], v[114:117], v[4:7]
    v_mfma_f32_16x16x32_bf16 v[8:11], v[192:195], v[118:121], v[8:11]
    ds_read_b64_tr_b16 v[220:221], v107 offset:40960
    ds_read_b64_tr_b16 v[222:223], v107 offset:45056
    s_waitcnt lgkmcnt(12)
    v_mfma_f32_16x16x32_bf16 v[12:15], v[196:199], v[110:113], v[12:15]
    v_mfma_f32_16x16x32_bf16 v[16:19], v[196:199], v[114:117], v[16:19]
    v_mfma_f32_16x16x32_bf16 v[20:23], v[196:199], v[118:121], v[20:23]
    ds_read_b64_tr_b16 v[192:193], v100 offset:49152
    ds_read_b64_tr_b16 v[194:195], v100 offset:53248
    s_waitcnt lgkmcnt(12)
    v_mfma_f32_16x16x32_bf16 v[24:27], v[200:203], v[110:113], v[24:27]
    v_mfma_f32_16x16x32_bf16 v[28:31], v[200:203], v[114:117], v[28:31]
    v_mfma_f32_16x16x32_bf16 v[32:35], v[200:203], v[118:121], v[32:35]
    ds_read_b64_tr_b16 v[196:197], v101 offset:49152
    ds_read_b64_tr_b16 v[198:199], v101 offset:53248
    s_waitcnt lgkmcnt(12)
    v_mfma_f32_16x16x32_bf16 v[36:39], v[204:207], v[110:113], v[36:39]
    v_mfma_f32_16x16x32_bf16 v[40:43], v[204:207], v[114:117], v[40:43]
    v_mfma_f32_16x16x32_bf16 v[44:47], v[204:207], v[118:121], v[44:47]
    ds_read_b64_tr_b16 v[200:201], v102 offset:49152
    ds_read_b64_tr_b16 v[202:203], v102 offset:53248
    s_waitcnt lgkmcnt(12)
    v_mfma_f32_16x16x32_bf16 v[48:51], v[208:211], v[110:113], v[48:51]
    v_mfma_f32_16x16x32_bf16 v[52:55], v[208:211], v[114:117], v[52:55]
    v_mfma_f32_16x16x32_bf16 v[56:59], v[208:211], v[118:121], v[56:59]
    ds_read_b64_tr_b16 v[204:205], v103 offset:49152
    ds_read_b64_tr_b16 v[206:207], v103 offset:53248
    s_waitcnt lgkmcnt(12)
    v_mfma_f32_16x16x32_bf16 v[60:63], v[212:215], v[110:113], v[60:63]
    v_mfma_f32_16x16x32_bf16 v[64:67], v[212:215], v[114:117], v[64:67]
    v_mfma_f32_16x16x32_bf16 v[68:71], v[212:215], v[118:121], v[68:71]
    ds_read_b64_tr_b16 v[208:209], v104 offset:49152
    ds_read_b64_tr_b16 v[210:211], v104 offset:53248
    s_waitcnt lgkmcnt(12)
    v_mfma_f32_16x16x32_bf16 v[72:75], v[216:219], v[110:113], v[72:75]
    v_mfma_f32_16x16x32_bf16 v[76:79], v[216:219], v[114:117], v[76:79]
    v_mfma_f32_16x16x32_bf16 v[80:83], v[216:219], v[118:121], v[80:83]
    ds_read_b64_tr_b16 v[212:213], v105 offset:49152
    ds_read_b64_tr_b16 v[214:215], v105 offset:53248
    s_waitcnt lgkmcnt(12)
    v_mfma_f32_16x16x32_bf16 v[84:87], v[220:223], v[110:113], v[84:87]
    v_mfma_f32_16x16x32_bf16 v[88:91], v[220:223], v[114:117], v[88:91]
    v_mfma_f32_16x16x32_bf16 v[92:95], v[220:223], v[118:121], v[92:95]
    ds_read_b64_tr_b16 v[216:217], v106 offset:49152
    ds_read_b64_tr_b16 v[218:219], v106 offset:53248
    s_waitcnt lgkmcnt(12)
    v_mfma_f32_16x16x32_bf16 v[0:3], v[192:195], v[122:125], v[0:3]
    v_mfma_f32_16x16x32_bf16 v[4:7], v[192:195], v[126:129], v[4:7]
    v_mfma_f32_16x16x32_bf16 v[8:11], v[192:195], v[130:133], v[8:11]
    ds_read_b64_tr_b16 v[220:221], v107 offset:49152
    ds_read_b64_tr_b16 v[222:223], v107 offset:53248
    s_waitcnt lgkmcnt(12)
    v_mfma_f32_16x16x32_bf16 v[12:15], v[196:199], v[122:125], v[12:15]
    v_mfma_f32_16x16x32_bf16 v[16:19], v[196:199], v[126:129], v[16:19]
    v_mfma_f32_16x16x32_bf16 v[20:23], v[196:199], v[130:133], v[20:23]
    s_waitcnt lgkmcnt(10)
    v_mfma_f32_16x16x32_bf16 v[24:27], v[200:203], v[122:125], v[24:27]
    v_mfma_f32_16x16x32_bf16 v[28:31], v[200:203], v[126:129], v[28:31]
    v_mfma_f32_16x16x32_bf16 v[32:35], v[200:203], v[130:133], v[32:35]
    s_waitcnt lgkmcnt(8)
    v_mfma_f32_16x16x32_bf16 v[36:39], v[204:207], v[122:125], v[36:39]
    v_mfma_f32_16x16x32_bf16 v[40:43], v[204:207], v[126:129], v[40:43]
    v_mfma_f32_16x16x32_bf16 v[44:47], v[204:207], v[130:133], v[44:47]
    s_waitcnt lgkmcnt(6)
    v_mfma_f32_16x16x32_bf16 v[48:51], v[208:211], v[122:125], v[48:51]
    v_mfma_f32_16x16x32_bf16 v[52:55], v[208:211], v[126:129], v[52:55]
    v_mfma_f32_16x16x32_bf16 v[56:59], v[208:211], v[130:133], v[56:59]
    s_waitcnt lgkmcnt(4)
    v_mfma_f32_16x16x32_bf16 v[60:63], v[212:215], v[122:125], v[60:63]
    v_mfma_f32_16x16x32_bf16 v[64:67], v[212:215], v[126:129], v[64:67]
    v_mfma_f32_16x16x32_bf16 v[68:71], v[212:215], v[130:133], v[68:71]
    s_waitcnt lgkmcnt(2)
    v_mfma_f32_16x16x32_bf16 v[72:75], v[216:219], v[122:125], v[72:75]
    v_mfma_f32_16x16x32_bf16 v[76:79], v[216:219], v[126:129], v[76:79]
    v_mfma_f32_16x16x32_bf16 v[80:83], v[216:219], v[130:133], v[80:83]
    s_waitcnt lgkmcnt(0)
    v_mfma_f32_16x16x32_bf16 v[84:87], v[220:223], v[122:125], v[84:87]
    v_mfma_f32_16x16x32_bf16 v[88:91], v[220:223], v[126:129], v[88:91]
    v_mfma_f32_16x16x32_bf16 v[92:95], v[220:223], v[130:133], v[92:95]
    s_waitcnt vmcnt(20)
    s_barrier
    ds_read_b128 v[110:113], v253 offset:16384
    ds_read_b128 v[122:125], v253 offset:17408
    ds_read_b128 v[114:117], v253 offset:18432
    ds_read_b128 v[126:129], v253 offset:19456
    ds_read_b128 v[118:121], v253 offset:20480
    ds_read_b128 v[130:133], v253 offset:21504
    s_add_u32 s57, s58, 15
    s_and_b32 s57, s57, 15
    s_lshl_b32 s59, s57, 11
    s_lshl_b32 s57, s57, 16
    s_add_u32 m0, s29, 122880
    s_add_u32 s32, s57, 0
    buffer_load_dwordx4 v236, s[8:11], s32 offen offset:0 lds
    s_add_u32 s32, s57, 3072
    buffer_load_dwordx4 v237, s[8:11], s32 offen offset:1024 lds
    s_add_u32 s32, s57, 6144
    buffer_load_dwordx4 v236, s[8:11], s32 offen offset:2048 lds
    s_add_u32 s32, s57, 9216
    buffer_load_dwordx4 v237, s[8:11], s32 offen offset:3072 lds
    s_add_u32 m0, s33, 139264
    s_add_u32 s32, s59, 0
    buffer_load_dwordx4 v252, s[12:15], s32 offen lds
    buffer_load_dwordx4 v252, s[12:15], s32 offen offset:1024 lds
    s_add_u32 m0, s33, 141312
    s_add_u32 s32, s59, 131072
    buffer_load_dwordx4 v252, s[12:15], s32 offen lds
    buffer_load_dwordx4 v252, s[12:15], s32 offen offset:1024 lds
    s_add_u32 m0, s33, 143360
    s_add_u32 s32, s59, 262144
    buffer_load_dwordx4 v252, s[12:15], s32 offen lds
    buffer_load_dwordx4 v252, s[12:15], s32 offen offset:1024 lds
    s_waitcnt lgkmcnt(0)
    ds_read_b64_tr_b16 v[192:193], v228 offset:0
    ds_read_b64_tr_b16 v[194:195], v228 offset:4096
    ds_read_b64_tr_b16 v[196:197], v229 offset:0
    ds_read_b64_tr_b16 v[198:199], v229 offset:4096
    ds_read_b64_tr_b16 v[200:201], v230 offset:0
    ds_read_b64_tr_b16 v[202:203], v230 offset:4096
    ds_read_b64_tr_b16 v[204:205], v231 offset:0
    ds_read_b64_tr_b16 v[206:207], v231 offset:4096
    ds_read_b64_tr_b16 v[208:209], v232 offset:0
    ds_read_b64_tr_b16 v[210:211], v232 offset:4096
    ds_read_b64_tr_b16 v[212:213], v233 offset:0
    ds_read_b64_tr_b16 v[214:215], v233 offset:4096
    ds_read_b64_tr_b16 v[216:217], v234 offset:0
    ds_read_b64_tr_b16 v[218:219], v234 offset:4096
    s_waitcnt lgkmcnt(12)
    v_mfma_f32_16x16x32_bf16 v[0:3], v[192:195], v[110:113], v[0:3]
    v_mfma_f32_16x16x32_bf16 v[4:7], v[192:195], v[114:117], v[4:7]
    v_mfma_f32_16x16x32_bf16 v[8:11], v[192:195], v[118:121], v[8:11]
    ds_read_b64_tr_b16 v[220:221], v235 offset:0
    ds_read_b64_tr_b16 v[222:223], v235 offset:4096
    s_waitcnt lgkmcnt(12)
    v_mfma_f32_16x16x32_bf16 v[12:15], v[196:199], v[110:113], v[12:15]
    v_mfma_f32_16x16x32_bf16 v[16:19], v[196:199], v[114:117], v[16:19]
    v_mfma_f32_16x16x32_bf16 v[20:23], v[196:199], v[118:121], v[20:23]
    ds_read_b64_tr_b16 v[192:193], v228 offset:8192
    ds_read_b64_tr_b16 v[194:195], v228 offset:12288
    s_waitcnt lgkmcnt(12)
    v_mfma_f32_16x16x32_bf16 v[24:27], v[200:203], v[110:113], v[24:27]
    v_mfma_f32_16x16x32_bf16 v[28:31], v[200:203], v[114:117], v[28:31]
    v_mfma_f32_16x16x32_bf16 v[32:35], v[200:203], v[118:121], v[32:35]
    ds_read_b64_tr_b16 v[196:197], v229 offset:8192
    ds_read_b64_tr_b16 v[198:199], v229 offset:12288
    s_waitcnt lgkmcnt(12)
    v_mfma_f32_16x16x32_bf16 v[36:39], v[204:207], v[110:113], v[36:39]
    v_mfma_f32_16x16x32_bf16 v[40:43], v[204:207], v[114:117], v[40:43]
    v_mfma_f32_16x16x32_bf16 v[44:47], v[204:207], v[118:121], v[44:47]
    ds_read_b64_tr_b16 v[200:201], v230 offset:8192
    ds_read_b64_tr_b16 v[202:203], v230 offset:12288
    s_waitcnt lgkmcnt(12)
    v_mfma_f32_16x16x32_bf16 v[48:51], v[208:211], v[110:113], v[48:51]
    v_mfma_f32_16x16x32_bf16 v[52:55], v[208:211], v[114:117], v[52:55]
    v_mfma_f32_16x16x32_bf16 v[56:59], v[208:211], v[118:121], v[56:59]
    ds_read_b64_tr_b16 v[204:205], v231 offset:8192
    ds_read_b64_tr_b16 v[206:207], v231 offset:12288
    s_waitcnt lgkmcnt(12)
    v_mfma_f32_16x16x32_bf16 v[60:63], v[212:215], v[110:113], v[60:63]
    v_mfma_f32_16x16x32_bf16 v[64:67], v[212:215], v[114:117], v[64:67]
    v_mfma_f32_16x16x32_bf16 v[68:71], v[212:215], v[118:121], v[68:71]
    ds_read_b64_tr_b16 v[208:209], v232 offset:8192
    ds_read_b64_tr_b16 v[210:211], v232 offset:12288
    s_waitcnt lgkmcnt(12)
    v_mfma_f32_16x16x32_bf16 v[72:75], v[216:219], v[110:113], v[72:75]
    v_mfma_f32_16x16x32_bf16 v[76:79], v[216:219], v[114:117], v[76:79]
    v_mfma_f32_16x16x32_bf16 v[80:83], v[216:219], v[118:121], v[80:83]
    ds_read_b64_tr_b16 v[212:213], v233 offset:8192
    ds_read_b64_tr_b16 v[214:215], v233 offset:12288
    s_waitcnt lgkmcnt(12)
    v_mfma_f32_16x16x32_bf16 v[84:87], v[220:223], v[110:113], v[84:87]
    v_mfma_f32_16x16x32_bf16 v[88:91], v[220:223], v[114:117], v[88:91]
    v_mfma_f32_16x16x32_bf16 v[92:95], v[220:223], v[118:121], v[92:95]
    ds_read_b64_tr_b16 v[216:217], v234 offset:8192
    ds_read_b64_tr_b16 v[218:219], v234 offset:12288
    s_waitcnt lgkmcnt(12)
    v_mfma_f32_16x16x32_bf16 v[0:3], v[192:195], v[122:125], v[0:3]
    v_mfma_f32_16x16x32_bf16 v[4:7], v[192:195], v[126:129], v[4:7]
    v_mfma_f32_16x16x32_bf16 v[8:11], v[192:195], v[130:133], v[8:11]
    ds_read_b64_tr_b16 v[220:221], v235 offset:8192
    ds_read_b64_tr_b16 v[222:223], v235 offset:12288
    s_waitcnt lgkmcnt(12)
    v_mfma_f32_16x16x32_bf16 v[12:15], v[196:199], v[122:125], v[12:15]
    v_mfma_f32_16x16x32_bf16 v[16:19], v[196:199], v[126:129], v[16:19]
    v_mfma_f32_16x16x32_bf16 v[20:23], v[196:199], v[130:133], v[20:23]
    s_waitcnt lgkmcnt(10)
    v_mfma_f32_16x16x32_bf16 v[24:27], v[200:203], v[122:125], v[24:27]
    v_mfma_f32_16x16x32_bf16 v[28:31], v[200:203], v[126:129], v[28:31]
    v_mfma_f32_16x16x32_bf16 v[32:35], v[200:203], v[130:133], v[32:35]
    s_waitcnt lgkmcnt(8)
    v_mfma_f32_16x16x32_bf16 v[36:39], v[204:207], v[122:125], v[36:39]
    v_mfma_f32_16x16x32_bf16 v[40:43], v[204:207], v[126:129], v[40:43]
    v_mfma_f32_16x16x32_bf16 v[44:47], v[204:207], v[130:133], v[44:47]
    s_waitcnt lgkmcnt(6)
    v_mfma_f32_16x16x32_bf16 v[48:51], v[208:211], v[122:125], v[48:51]
    v_mfma_f32_16x16x32_bf16 v[52:55], v[208:211], v[126:129], v[52:55]
    v_mfma_f32_16x16x32_bf16 v[56:59], v[208:211], v[130:133], v[56:59]
    s_waitcnt lgkmcnt(4)
    v_mfma_f32_16x16x32_bf16 v[60:63], v[212:215], v[122:125], v[60:63]
    v_mfma_f32_16x16x32_bf16 v[64:67], v[212:215], v[126:129], v[64:67]
    v_mfma_f32_16x16x32_bf16 v[68:71], v[212:215], v[130:133], v[68:71]
    s_waitcnt lgkmcnt(2)
    v_mfma_f32_16x16x32_bf16 v[72:75], v[216:219], v[122:125], v[72:75]
    v_mfma_f32_16x16x32_bf16 v[76:79], v[216:219], v[126:129], v[76:79]
    v_mfma_f32_16x16x32_bf16 v[80:83], v[216:219], v[130:133], v[80:83]
    s_waitcnt lgkmcnt(0)
    v_mfma_f32_16x16x32_bf16 v[84:87], v[220:223], v[122:125], v[84:87]
    v_mfma_f32_16x16x32_bf16 v[88:91], v[220:223], v[126:129], v[88:91]
    v_mfma_f32_16x16x32_bf16 v[92:95], v[220:223], v[130:133], v[92:95]
    s_waitcnt vmcnt(20)
    s_barrier
    ds_read_b128 v[110:113], v253 offset:57344
    ds_read_b128 v[122:125], v253 offset:58368
    ds_read_b128 v[114:117], v253 offset:59392
    ds_read_b128 v[126:129], v253 offset:60416
    ds_read_b128 v[118:121], v253 offset:61440
    ds_read_b128 v[130:133], v253 offset:62464
    s_waitcnt lgkmcnt(0)
    ds_read_b64_tr_b16 v[192:193], v228 offset:40960
    ds_read_b64_tr_b16 v[194:195], v228 offset:45056
    ds_read_b64_tr_b16 v[196:197], v229 offset:40960
    ds_read_b64_tr_b16 v[198:199], v229 offset:45056
    ds_read_b64_tr_b16 v[200:201], v230 offset:40960
    ds_read_b64_tr_b16 v[202:203], v230 offset:45056
    ds_read_b64_tr_b16 v[204:205], v231 offset:40960
    ds_read_b64_tr_b16 v[206:207], v231 offset:45056
    ds_read_b64_tr_b16 v[208:209], v232 offset:40960
    ds_read_b64_tr_b16 v[210:211], v232 offset:45056
    ds_read_b64_tr_b16 v[212:213], v233 offset:40960
    ds_read_b64_tr_b16 v[214:215], v233 offset:45056
    ds_read_b64_tr_b16 v[216:217], v234 offset:40960
    ds_read_b64_tr_b16 v[218:219], v234 offset:45056
    s_waitcnt lgkmcnt(12)
    v_mfma_f32_16x16x32_bf16 v[0:3], v[192:195], v[110:113], v[0:3]
    v_mfma_f32_16x16x32_bf16 v[4:7], v[192:195], v[114:117], v[4:7]
    v_mfma_f32_16x16x32_bf16 v[8:11], v[192:195], v[118:121], v[8:11]
    ds_read_b64_tr_b16 v[220:221], v235 offset:40960
    ds_read_b64_tr_b16 v[222:223], v235 offset:45056
    s_waitcnt lgkmcnt(12)
    v_mfma_f32_16x16x32_bf16 v[12:15], v[196:199], v[110:113], v[12:15]
    v_mfma_f32_16x16x32_bf16 v[16:19], v[196:199], v[114:117], v[16:19]
    v_mfma_f32_16x16x32_bf16 v[20:23], v[196:199], v[118:121], v[20:23]
    ds_read_b64_tr_b16 v[192:193], v228 offset:49152
    ds_read_b64_tr_b16 v[194:195], v228 offset:53248
    s_waitcnt lgkmcnt(12)
    v_mfma_f32_16x16x32_bf16 v[24:27], v[200:203], v[110:113], v[24:27]
    v_mfma_f32_16x16x32_bf16 v[28:31], v[200:203], v[114:117], v[28:31]
    v_mfma_f32_16x16x32_bf16 v[32:35], v[200:203], v[118:121], v[32:35]
    ds_read_b64_tr_b16 v[196:197], v229 offset:49152
    ds_read_b64_tr_b16 v[198:199], v229 offset:53248
    s_waitcnt lgkmcnt(12)
    v_mfma_f32_16x16x32_bf16 v[36:39], v[204:207], v[110:113], v[36:39]
    v_mfma_f32_16x16x32_bf16 v[40:43], v[204:207], v[114:117], v[40:43]
    v_mfma_f32_16x16x32_bf16 v[44:47], v[204:207], v[118:121], v[44:47]
    ds_read_b64_tr_b16 v[200:201], v230 offset:49152
    ds_read_b64_tr_b16 v[202:203], v230 offset:53248
    s_waitcnt lgkmcnt(12)
    v_mfma_f32_16x16x32_bf16 v[48:51], v[208:211], v[110:113], v[48:51]
    v_mfma_f32_16x16x32_bf16 v[52:55], v[208:211], v[114:117], v[52:55]
    v_mfma_f32_16x16x32_bf16 v[56:59], v[208:211], v[118:121], v[56:59]
    ds_read_b64_tr_b16 v[204:205], v231 offset:49152
    ds_read_b64_tr_b16 v[206:207], v231 offset:53248
    s_waitcnt lgkmcnt(12)
    v_mfma_f32_16x16x32_bf16 v[60:63], v[212:215], v[110:113], v[60:63]
    v_mfma_f32_16x16x32_bf16 v[64:67], v[212:215], v[114:117], v[64:67]
    v_mfma_f32_16x16x32_bf16 v[68:71], v[212:215], v[118:121], v[68:71]
    ds_read_b64_tr_b16 v[208:209], v232 offset:49152
    ds_read_b64_tr_b16 v[210:211], v232 offset:53248
    s_waitcnt lgkmcnt(12)
    v_mfma_f32_16x16x32_bf16 v[72:75], v[216:219], v[110:113], v[72:75]
    v_mfma_f32_16x16x32_bf16 v[76:79], v[216:219], v[114:117], v[76:79]
    v_mfma_f32_16x16x32_bf16 v[80:83], v[216:219], v[118:121], v[80:83]
    ds_read_b64_tr_b16 v[212:213], v233 offset:49152
    ds_read_b64_tr_b16 v[214:215], v233 offset:53248
    s_waitcnt lgkmcnt(12)
    v_mfma_f32_16x16x32_bf16 v[84:87], v[220:223], v[110:113], v[84:87]
    v_mfma_f32_16x16x32_bf16 v[88:91], v[220:223], v[114:117], v[88:91]
    v_mfma_f32_16x16x32_bf16 v[92:95], v[220:223], v[118:121], v[92:95]
    ds_read_b64_tr_b16 v[216:217], v234 offset:49152
    ds_read_b64_tr_b16 v[218:219], v234 offset:53248
    s_waitcnt lgkmcnt(12)
    v_mfma_f32_16x16x32_bf16 v[0:3], v[192:195], v[122:125], v[0:3]
    v_mfma_f32_16x16x32_bf16 v[4:7], v[192:195], v[126:129], v[4:7]
    v_mfma_f32_16x16x32_bf16 v[8:11], v[192:195], v[130:133], v[8:11]
    ds_read_b64_tr_b16 v[220:221], v235 offset:49152
    ds_read_b64_tr_b16 v[222:223], v235 offset:53248
    s_waitcnt lgkmcnt(12)
    v_mfma_f32_16x16x32_bf16 v[12:15], v[196:199], v[122:125], v[12:15]
    v_mfma_f32_16x16x32_bf16 v[16:19], v[196:199], v[126:129], v[16:19]
    v_mfma_f32_16x16x32_bf16 v[20:23], v[196:199], v[130:133], v[20:23]
    s_waitcnt lgkmcnt(10)
    v_mfma_f32_16x16x32_bf16 v[24:27], v[200:203], v[122:125], v[24:27]
    v_mfma_f32_16x16x32_bf16 v[28:31], v[200:203], v[126:129], v[28:31]
    v_mfma_f32_16x16x32_bf16 v[32:35], v[200:203], v[130:133], v[32:35]
    s_waitcnt lgkmcnt(8)
    v_mfma_f32_16x16x32_bf16 v[36:39], v[204:207], v[122:125], v[36:39]
    v_mfma_f32_16x16x32_bf16 v[40:43], v[204:207], v[126:129], v[40:43]
    v_mfma_f32_16x16x32_bf16 v[44:47], v[204:207], v[130:133], v[44:47]
    s_waitcnt lgkmcnt(6)
    v_mfma_f32_16x16x32_bf16 v[48:51], v[208:211], v[122:125], v[48:51]
    v_mfma_f32_16x16x32_bf16 v[52:55], v[208:211], v[126:129], v[52:55]
    v_mfma_f32_16x16x32_bf16 v[56:59], v[208:211], v[130:133], v[56:59]
    s_waitcnt lgkmcnt(4)
    v_mfma_f32_16x16x32_bf16 v[60:63], v[212:215], v[122:125], v[60:63]
    v_mfma_f32_16x16x32_bf16 v[64:67], v[212:215], v[126:129], v[64:67]
    v_mfma_f32_16x16x32_bf16 v[68:71], v[212:215], v[130:133], v[68:71]
    s_waitcnt lgkmcnt(2)
    v_mfma_f32_16x16x32_bf16 v[72:75], v[216:219], v[122:125], v[72:75]
    v_mfma_f32_16x16x32_bf16 v[76:79], v[216:219], v[126:129], v[76:79]
    v_mfma_f32_16x16x32_bf16 v[80:83], v[216:219], v[130:133], v[80:83]
    s_waitcnt lgkmcnt(0)
    v_mfma_f32_16x16x32_bf16 v[84:87], v[220:223], v[122:125], v[84:87]
    v_mfma_f32_16x16x32_bf16 v[88:91], v[220:223], v[126:129], v[88:91]
    v_mfma_f32_16x16x32_bf16 v[92:95], v[220:223], v[130:133], v[92:95]
    s_waitcnt vmcnt(10)
    s_barrier
    ds_read_b128 v[110:113], v254 offset:16384
    ds_read_b128 v[122:125], v254 offset:17408
    ds_read_b128 v[114:117], v254 offset:18432
    ds_read_b128 v[126:129], v254 offset:19456
    ds_read_b128 v[118:121], v254 offset:20480
    ds_read_b128 v[130:133], v254 offset:21504
    s_waitcnt lgkmcnt(0)
    ds_read_b64_tr_b16 v[192:193], v100 offset:0
    ds_read_b64_tr_b16 v[194:195], v100 offset:4096
    ds_read_b64_tr_b16 v[196:197], v101 offset:0
    ds_read_b64_tr_b16 v[198:199], v101 offset:4096
    ds_read_b64_tr_b16 v[200:201], v102 offset:0
    ds_read_b64_tr_b16 v[202:203], v102 offset:4096
    ds_read_b64_tr_b16 v[204:205], v103 offset:0
    ds_read_b64_tr_b16 v[206:207], v103 offset:4096
    ds_read_b64_tr_b16 v[208:209], v104 offset:0
    ds_read_b64_tr_b16 v[210:211], v104 offset:4096
    ds_read_b64_tr_b16 v[212:213], v105 offset:0
    ds_read_b64_tr_b16 v[214:215], v105 offset:4096
    ds_read_b64_tr_b16 v[216:217], v106 offset:0
    ds_read_b64_tr_b16 v[218:219], v106 offset:4096
    s_waitcnt lgkmcnt(12)
    v_mfma_f32_16x16x32_bf16 v[0:3], v[192:195], v[110:113], v[0:3]
    v_mfma_f32_16x16x32_bf16 v[4:7], v[192:195], v[114:117], v[4:7]
    v_mfma_f32_16x16x32_bf16 v[8:11], v[192:195], v[118:121], v[8:11]
    ds_read_b64_tr_b16 v[220:221], v107 offset:0
    ds_read_b64_tr_b16 v[222:223], v107 offset:4096
    s_waitcnt lgkmcnt(12)
    v_mfma_f32_16x16x32_bf16 v[12:15], v[196:199], v[110:113], v[12:15]
    v_mfma_f32_16x16x32_bf16 v[16:19], v[196:199], v[114:117], v[16:19]
    v_mfma_f32_16x16x32_bf16 v[20:23], v[196:199], v[118:121], v[20:23]
    ds_read_b64_tr_b16 v[192:193], v100 offset:8192
    ds_read_b64_tr_b16 v[194:195], v100 offset:12288
    s_waitcnt lgkmcnt(12)
    v_mfma_f32_16x16x32_bf16 v[24:27], v[200:203], v[110:113], v[24:27]
    v_mfma_f32_16x16x32_bf16 v[28:31], v[200:203], v[114:117], v[28:31]
    v_mfma_f32_16x16x32_bf16 v[32:35], v[200:203], v[118:121], v[32:35]
    ds_read_b64_tr_b16 v[196:197], v101 offset:8192
    ds_read_b64_tr_b16 v[198:199], v101 offset:12288
    s_waitcnt lgkmcnt(12)
    v_mfma_f32_16x16x32_bf16 v[36:39], v[204:207], v[110:113], v[36:39]
    v_mfma_f32_16x16x32_bf16 v[40:43], v[204:207], v[114:117], v[40:43]
    v_mfma_f32_16x16x32_bf16 v[44:47], v[204:207], v[118:121], v[44:47]
    ds_read_b64_tr_b16 v[200:201], v102 offset:8192
    ds_read_b64_tr_b16 v[202:203], v102 offset:12288
    s_waitcnt lgkmcnt(12)
    v_mfma_f32_16x16x32_bf16 v[48:51], v[208:211], v[110:113], v[48:51]
    v_mfma_f32_16x16x32_bf16 v[52:55], v[208:211], v[114:117], v[52:55]
    v_mfma_f32_16x16x32_bf16 v[56:59], v[208:211], v[118:121], v[56:59]
    ds_read_b64_tr_b16 v[204:205], v103 offset:8192
    ds_read_b64_tr_b16 v[206:207], v103 offset:12288
    s_waitcnt lgkmcnt(12)
    v_mfma_f32_16x16x32_bf16 v[60:63], v[212:215], v[110:113], v[60:63]
    v_mfma_f32_16x16x32_bf16 v[64:67], v[212:215], v[114:117], v[64:67]
    v_mfma_f32_16x16x32_bf16 v[68:71], v[212:215], v[118:121], v[68:71]
    ds_read_b64_tr_b16 v[208:209], v104 offset:8192
    ds_read_b64_tr_b16 v[210:211], v104 offset:12288
    s_waitcnt lgkmcnt(12)
    v_mfma_f32_16x16x32_bf16 v[72:75], v[216:219], v[110:113], v[72:75]
    v_mfma_f32_16x16x32_bf16 v[76:79], v[216:219], v[114:117], v[76:79]
    v_mfma_f32_16x16x32_bf16 v[80:83], v[216:219], v[118:121], v[80:83]
    ds_read_b64_tr_b16 v[212:213], v105 offset:8192
    ds_read_b64_tr_b16 v[214:215], v105 offset:12288
    s_waitcnt lgkmcnt(12)
    v_mfma_f32_16x16x32_bf16 v[84:87], v[220:223], v[110:113], v[84:87]
    v_mfma_f32_16x16x32_bf16 v[88:91], v[220:223], v[114:117], v[88:91]
    v_mfma_f32_16x16x32_bf16 v[92:95], v[220:223], v[118:121], v[92:95]
    ds_read_b64_tr_b16 v[216:217], v106 offset:8192
    ds_read_b64_tr_b16 v[218:219], v106 offset:12288
    s_waitcnt lgkmcnt(12)
    v_mfma_f32_16x16x32_bf16 v[0:3], v[192:195], v[122:125], v[0:3]
    v_mfma_f32_16x16x32_bf16 v[4:7], v[192:195], v[126:129], v[4:7]
    v_mfma_f32_16x16x32_bf16 v[8:11], v[192:195], v[130:133], v[8:11]
    ds_read_b64_tr_b16 v[220:221], v107 offset:8192
    ds_read_b64_tr_b16 v[222:223], v107 offset:12288
    s_waitcnt lgkmcnt(12)
    v_mfma_f32_16x16x32_bf16 v[12:15], v[196:199], v[122:125], v[12:15]
    v_mfma_f32_16x16x32_bf16 v[16:19], v[196:199], v[126:129], v[16:19]
    v_mfma_f32_16x16x32_bf16 v[20:23], v[196:199], v[130:133], v[20:23]
    s_waitcnt lgkmcnt(10)
    v_mfma_f32_16x16x32_bf16 v[24:27], v[200:203], v[122:125], v[24:27]
    v_mfma_f32_16x16x32_bf16 v[28:31], v[200:203], v[126:129], v[28:31]
    v_mfma_f32_16x16x32_bf16 v[32:35], v[200:203], v[130:133], v[32:35]
    s_waitcnt lgkmcnt(8)
    v_mfma_f32_16x16x32_bf16 v[36:39], v[204:207], v[122:125], v[36:39]
    v_mfma_f32_16x16x32_bf16 v[40:43], v[204:207], v[126:129], v[40:43]
    v_mfma_f32_16x16x32_bf16 v[44:47], v[204:207], v[130:133], v[44:47]
    s_waitcnt lgkmcnt(6)
    v_mfma_f32_16x16x32_bf16 v[48:51], v[208:211], v[122:125], v[48:51]
    v_mfma_f32_16x16x32_bf16 v[52:55], v[208:211], v[126:129], v[52:55]
    v_mfma_f32_16x16x32_bf16 v[56:59], v[208:211], v[130:133], v[56:59]
    s_waitcnt lgkmcnt(4)
    v_mfma_f32_16x16x32_bf16 v[60:63], v[212:215], v[122:125], v[60:63]
    v_mfma_f32_16x16x32_bf16 v[64:67], v[212:215], v[126:129], v[64:67]
    v_mfma_f32_16x16x32_bf16 v[68:71], v[212:215], v[130:133], v[68:71]
    s_waitcnt lgkmcnt(2)
    v_mfma_f32_16x16x32_bf16 v[72:75], v[216:219], v[122:125], v[72:75]
    v_mfma_f32_16x16x32_bf16 v[76:79], v[216:219], v[126:129], v[76:79]
    v_mfma_f32_16x16x32_bf16 v[80:83], v[216:219], v[130:133], v[80:83]
    s_waitcnt lgkmcnt(0)
    v_mfma_f32_16x16x32_bf16 v[84:87], v[220:223], v[122:125], v[84:87]
    v_mfma_f32_16x16x32_bf16 v[88:91], v[220:223], v[126:129], v[88:91]
    v_mfma_f32_16x16x32_bf16 v[92:95], v[220:223], v[130:133], v[92:95]
    s_waitcnt vmcnt(0)
    s_barrier
    ds_read_b128 v[110:113], v254 offset:57344
    ds_read_b128 v[122:125], v254 offset:58368
    ds_read_b128 v[114:117], v254 offset:59392
    ds_read_b128 v[126:129], v254 offset:60416
    ds_read_b128 v[118:121], v254 offset:61440
    ds_read_b128 v[130:133], v254 offset:62464
    s_waitcnt lgkmcnt(0)
    ds_read_b64_tr_b16 v[192:193], v100 offset:40960
    ds_read_b64_tr_b16 v[194:195], v100 offset:45056
    ds_read_b64_tr_b16 v[196:197], v101 offset:40960
    ds_read_b64_tr_b16 v[198:199], v101 offset:45056
    ds_read_b64_tr_b16 v[200:201], v102 offset:40960
    ds_read_b64_tr_b16 v[202:203], v102 offset:45056
    ds_read_b64_tr_b16 v[204:205], v103 offset:40960
    ds_read_b64_tr_b16 v[206:207], v103 offset:45056
    ds_read_b64_tr_b16 v[208:209], v104 offset:40960
    ds_read_b64_tr_b16 v[210:211], v104 offset:45056
    ds_read_b64_tr_b16 v[212:213], v105 offset:40960
    ds_read_b64_tr_b16 v[214:215], v105 offset:45056
    ds_read_b64_tr_b16 v[216:217], v106 offset:40960
    ds_read_b64_tr_b16 v[218:219], v106 offset:45056
    s_waitcnt lgkmcnt(12)
    v_mfma_f32_16x16x32_bf16 v[0:3], v[192:195], v[110:113], v[0:3]
    v_mfma_f32_16x16x32_bf16 v[4:7], v[192:195], v[114:117], v[4:7]
    v_mfma_f32_16x16x32_bf16 v[8:11], v[192:195], v[118:121], v[8:11]
    ds_read_b64_tr_b16 v[220:221], v107 offset:40960
    ds_read_b64_tr_b16 v[222:223], v107 offset:45056
    s_waitcnt lgkmcnt(12)
    v_mfma_f32_16x16x32_bf16 v[12:15], v[196:199], v[110:113], v[12:15]
    v_mfma_f32_16x16x32_bf16 v[16:19], v[196:199], v[114:117], v[16:19]
    v_mfma_f32_16x16x32_bf16 v[20:23], v[196:199], v[118:121], v[20:23]
    ds_read_b64_tr_b16 v[192:193], v100 offset:49152
    ds_read_b64_tr_b16 v[194:195], v100 offset:53248
    s_waitcnt lgkmcnt(12)
    v_mfma_f32_16x16x32_bf16 v[24:27], v[200:203], v[110:113], v[24:27]
    v_mfma_f32_16x16x32_bf16 v[28:31], v[200:203], v[114:117], v[28:31]
    v_mfma_f32_16x16x32_bf16 v[32:35], v[200:203], v[118:121], v[32:35]
    ds_read_b64_tr_b16 v[196:197], v101 offset:49152
    ds_read_b64_tr_b16 v[198:199], v101 offset:53248
    s_waitcnt lgkmcnt(12)
    v_mfma_f32_16x16x32_bf16 v[36:39], v[204:207], v[110:113], v[36:39]
    v_mfma_f32_16x16x32_bf16 v[40:43], v[204:207], v[114:117], v[40:43]
    v_mfma_f32_16x16x32_bf16 v[44:47], v[204:207], v[118:121], v[44:47]
    ds_read_b64_tr_b16 v[200:201], v102 offset:49152
    ds_read_b64_tr_b16 v[202:203], v102 offset:53248
    s_waitcnt lgkmcnt(12)
    v_mfma_f32_16x16x32_bf16 v[48:51], v[208:211], v[110:113], v[48:51]
    v_mfma_f32_16x16x32_bf16 v[52:55], v[208:211], v[114:117], v[52:55]
    v_mfma_f32_16x16x32_bf16 v[56:59], v[208:211], v[118:121], v[56:59]
    ds_read_b64_tr_b16 v[204:205], v103 offset:49152
    ds_read_b64_tr_b16 v[206:207], v103 offset:53248
    s_waitcnt lgkmcnt(12)
    v_mfma_f32_16x16x32_bf16 v[60:63], v[212:215], v[110:113], v[60:63]
    v_mfma_f32_16x16x32_bf16 v[64:67], v[212:215], v[114:117], v[64:67]
    v_mfma_f32_16x16x32_bf16 v[68:71], v[212:215], v[118:121], v[68:71]
    ds_read_b64_tr_b16 v[208:209], v104 offset:49152
    ds_read_b64_tr_b16 v[210:211], v104 offset:53248
    s_waitcnt lgkmcnt(12)
    v_mfma_f32_16x16x32_bf16 v[72:75], v[216:219], v[110:113], v[72:75]
    v_mfma_f32_16x16x32_bf16 v[76:79], v[216:219], v[114:117], v[76:79]
    v_mfma_f32_16x16x32_bf16 v[80:83], v[216:219], v[118:121], v[80:83]
    ds_read_b64_tr_b16 v[212:213], v105 offset:49152
    ds_read_b64_tr_b16 v[214:215], v105 offset:53248
    s_waitcnt lgkmcnt(12)
    v_mfma_f32_16x16x32_bf16 v[84:87], v[220:223], v[110:113], v[84:87]
    v_mfma_f32_16x16x32_bf16 v[88:91], v[220:223], v[114:117], v[88:91]
    v_mfma_f32_16x16x32_bf16 v[92:95], v[220:223], v[118:121], v[92:95]
    ds_read_b64_tr_b16 v[216:217], v106 offset:49152
    ds_read_b64_tr_b16 v[218:219], v106 offset:53248
    s_waitcnt lgkmcnt(12)
    v_mfma_f32_16x16x32_bf16 v[0:3], v[192:195], v[122:125], v[0:3]
    v_mfma_f32_16x16x32_bf16 v[4:7], v[192:195], v[126:129], v[4:7]
    v_mfma_f32_16x16x32_bf16 v[8:11], v[192:195], v[130:133], v[8:11]
    ds_read_b64_tr_b16 v[220:221], v107 offset:49152
    ds_read_b64_tr_b16 v[222:223], v107 offset:53248
    s_waitcnt lgkmcnt(12)
    v_mfma_f32_16x16x32_bf16 v[12:15], v[196:199], v[122:125], v[12:15]
    v_mfma_f32_16x16x32_bf16 v[16:19], v[196:199], v[126:129], v[16:19]
    v_mfma_f32_16x16x32_bf16 v[20:23], v[196:199], v[130:133], v[20:23]
    s_waitcnt lgkmcnt(10)
    v_mfma_f32_16x16x32_bf16 v[24:27], v[200:203], v[122:125], v[24:27]
    v_mfma_f32_16x16x32_bf16 v[28:31], v[200:203], v[126:129], v[28:31]
    v_mfma_f32_16x16x32_bf16 v[32:35], v[200:203], v[130:133], v[32:35]
    s_waitcnt lgkmcnt(8)
    v_mfma_f32_16x16x32_bf16 v[36:39], v[204:207], v[122:125], v[36:39]
    v_mfma_f32_16x16x32_bf16 v[40:43], v[204:207], v[126:129], v[40:43]
    v_mfma_f32_16x16x32_bf16 v[44:47], v[204:207], v[130:133], v[44:47]
    s_waitcnt lgkmcnt(6)
    v_mfma_f32_16x16x32_bf16 v[48:51], v[208:211], v[122:125], v[48:51]
    v_mfma_f32_16x16x32_bf16 v[52:55], v[208:211], v[126:129], v[52:55]
    v_mfma_f32_16x16x32_bf16 v[56:59], v[208:211], v[130:133], v[56:59]
    s_waitcnt lgkmcnt(4)
    v_mfma_f32_16x16x32_bf16 v[60:63], v[212:215], v[122:125], v[60:63]
    v_mfma_f32_16x16x32_bf16 v[64:67], v[212:215], v[126:129], v[64:67]
    v_mfma_f32_16x16x32_bf16 v[68:71], v[212:215], v[130:133], v[68:71]
    s_waitcnt lgkmcnt(2)
    v_mfma_f32_16x16x32_bf16 v[72:75], v[216:219], v[122:125], v[72:75]
    v_mfma_f32_16x16x32_bf16 v[76:79], v[216:219], v[126:129], v[76:79]
    v_mfma_f32_16x16x32_bf16 v[80:83], v[216:219], v[130:133], v[80:83]
    s_waitcnt lgkmcnt(0)
    v_mfma_f32_16x16x32_bf16 v[84:87], v[220:223], v[122:125], v[84:87]
    v_mfma_f32_16x16x32_bf16 v[88:91], v[220:223], v[126:129], v[88:91]
    v_mfma_f32_16x16x32_bf16 v[92:95], v[220:223], v[130:133], v[92:95]
    v_mbcnt_lo_u32_b32 v244, -1, 0
    v_mbcnt_hi_u32_b32 v244, -1, v244
    v_and_b32 v245, 15, v244
    v_lshrrev_b32 v246, 4, v244
    s_mul_i32 s32, s28, 48
    v_add_u32 v245, s32, v245
    v_lshlrev_b32 v245, 11, v245
    v_lshl_add_u32 v248, v246, 4, v245
    v_add_u32 v249, 0x8000, v248
    v_add_u32 v250, 0x10000, v248
    buffer_store_dwordx4 v[0:3], v248, s[16:19], 0 offen offset:0
    buffer_store_dwordx4 v[4:7], v249, s[16:19], 0 offen offset:0
    buffer_store_dwordx4 v[8:11], v250, s[16:19], 0 offen offset:0
    buffer_store_dwordx4 v[12:15], v248, s[16:19], 0 offen offset:64
    buffer_store_dwordx4 v[16:19], v249, s[16:19], 0 offen offset:64
    buffer_store_dwordx4 v[20:23], v250, s[16:19], 0 offen offset:64
    buffer_store_dwordx4 v[24:27], v248, s[16:19], 0 offen offset:128
    buffer_store_dwordx4 v[28:31], v249, s[16:19], 0 offen offset:128
    buffer_store_dwordx4 v[32:35], v250, s[16:19], 0 offen offset:128
    buffer_store_dwordx4 v[36:39], v248, s[16:19], 0 offen offset:192
    buffer_store_dwordx4 v[40:43], v249, s[16:19], 0 offen offset:192
    buffer_store_dwordx4 v[44:47], v250, s[16:19], 0 offen offset:192
    buffer_store_dwordx4 v[48:51], v248, s[16:19], 0 offen offset:256
    buffer_store_dwordx4 v[52:55], v249, s[16:19], 0 offen offset:256
    buffer_store_dwordx4 v[56:59], v250, s[16:19], 0 offen offset:256
    buffer_store_dwordx4 v[60:63], v248, s[16:19], 0 offen offset:320
    buffer_store_dwordx4 v[64:67], v249, s[16:19], 0 offen offset:320
    buffer_store_dwordx4 v[68:71], v250, s[16:19], 0 offen offset:320
    buffer_store_dwordx4 v[72:75], v248, s[16:19], 0 offen offset:384
    buffer_store_dwordx4 v[76:79], v249, s[16:19], 0 offen offset:384
    buffer_store_dwordx4 v[80:83], v250, s[16:19], 0 offen offset:384
    buffer_store_dwordx4 v[84:87], v248, s[16:19], 0 offen offset:448
    buffer_store_dwordx4 v[88:91], v249, s[16:19], 0 offen offset:448
    buffer_store_dwordx4 v[92:95], v250, s[16:19], 0 offen offset:448
L_oproj_end:
    s_endpgm
.globl reduce_kernel
.p2align 8
.type reduce_kernel,@function
reduce_kernel:
    s_cmp_ge_u32 s2, 768
    s_cbranch_scc1 L_red_end
    s_load_dwordx2 s[4:5], s[0:1], 80
    s_load_dwordx2 s[6:7], s[0:1], 96
    s_lshl_b32 s3, s2, 8
    v_add_u32 v1, s3, v0
    s_waitcnt lgkmcnt(0)
    s_add_u32 s8, s6, 0x2000000
    s_addc_u32 s9, s7, 0
    s_mov_b32 s10, 25165824
    s_mov_b32 s11, 0x00020000
    s_mov_b32 s12, s4
    s_mov_b32 s13, s5
    s_mov_b32 s14, 3145728
    s_mov_b32 s15, 0x00020000
    v_lshlrev_b32 v2, 5, v1
    s_mov_b32 s16, 6291456
    s_mul_i32 s17, s16, 0
    buffer_load_dwordx4 v[8:11], v2, s[8:11], s17 offen
    buffer_load_dwordx4 v[12:15], v2, s[8:11], s17 offen offset:16
    s_mul_i32 s17, s16, 1
    buffer_load_dwordx4 v[16:19], v2, s[8:11], s17 offen
    buffer_load_dwordx4 v[20:23], v2, s[8:11], s17 offen offset:16
    s_mul_i32 s17, s16, 2
    buffer_load_dwordx4 v[24:27], v2, s[8:11], s17 offen
    buffer_load_dwordx4 v[28:31], v2, s[8:11], s17 offen offset:16
    s_mul_i32 s17, s16, 3
    buffer_load_dwordx4 v[32:35], v2, s[8:11], s17 offen
    buffer_load_dwordx4 v[36:39], v2, s[8:11], s17 offen offset:16
    v_cmp_le_u32 vcc, 98304, v1
    v_cndmask_b32 v3, 0, 1, vcc
    v_mul_u32_u24 v4, 98304, v3
    v_sub_u32 v4, v1, v4
    v_lshrrev_b32 v5, 6, v4
    v_and_b32 v6, 63, v4
    v_lshlrev_b32 v5, 11, v5
    v_lshl_add_u32 v5, v3, 10, v5
    v_lshl_add_u32 v5, v6, 4, v5
    s_waitcnt vmcnt(0)
    v_add_f32 v8, v8, v16
    v_add_f32 v9, v9, v17
    v_add_f32 v10, v10, v18
    v_add_f32 v11, v11, v19
    v_add_f32 v12, v12, v20
    v_add_f32 v13, v13, v21
    v_add_f32 v14, v14, v22
    v_add_f32 v15, v15, v23
    v_add_f32 v8, v8, v24
    v_add_f32 v9, v9, v25
    v_add_f32 v10, v10, v26
    v_add_f32 v11, v11, v27
    v_add_f32 v12, v12, v28
    v_add_f32 v13, v13, v29
    v_add_f32 v14, v14, v30
    v_add_f32 v15, v15, v31
    v_add_f32 v8, v8, v32
    v_add_f32 v9, v9, v33
    v_add_f32 v10, v10, v34
    v_add_f32 v11, v11, v35
    v_add_f32 v12, v12, v36
    v_add_f32 v13, v13, v37
    v_add_f32 v14, v14, v38
    v_add_f32 v15, v15, v39
    v_cvt_pk_bf16_f32 v40, v8, v9
    v_cvt_pk_bf16_f32 v41, v10, v11
    v_cvt_pk_bf16_f32 v42, v12, v13
    v_cvt_pk_bf16_f32 v43, v14, v15
    buffer_store_dwordx4 v[40:43], v5, s[12:15], 0 offen
L_red_end:
    s_endpgm
.section .rodata,"a"
.p2align 6
.amdhsa_kernel attn_kernel
  .amdhsa_next_free_vgpr 256
  .amdhsa_next_free_sgpr 64
  .amdhsa_accum_offset 256
  .amdhsa_group_segment_fixed_size 0
  .amdhsa_kernarg_size 104
  .amdhsa_user_sgpr_count 2
  .amdhsa_user_sgpr_kernarg_segment_ptr 1
  .amdhsa_system_sgpr_workgroup_id_x 1
.end_amdhsa_kernel

.p2align 6
.amdhsa_kernel oproj_kernel
  .amdhsa_next_free_vgpr 256
  .amdhsa_next_free_sgpr 64
  .amdhsa_accum_offset 256
  .amdhsa_group_segment_fixed_size 0
  .amdhsa_kernarg_size 104
  .amdhsa_user_sgpr_count 2
  .amdhsa_user_sgpr_kernarg_segment_ptr 1
  .amdhsa_system_sgpr_workgroup_id_x 1
.end_amdhsa_kernel

.p2align 6
.amdhsa_kernel reduce_kernel
  .amdhsa_next_free_vgpr 48
  .amdhsa_next_free_sgpr 32
  .amdhsa_accum_offset 48
  .amdhsa_group_segment_fixed_size 0
  .amdhsa_kernarg_size 104
  .amdhsa_user_sgpr_count 2
  .amdhsa_user_sgpr_kernarg_segment_ptr 1
  .amdhsa_system_sgpr_workgroup_id_x 1
.end_amdhsa_kernel
```
